```python
import torch

def _softmax(x, axis=-1):
    return torch.softmax(x, dim=axis)
def _gelu(x):
    return torch.nn.functional.gelu(x, approximate="tanh")
def _silu(x):
    return torch.nn.functional.silu(x)
def _sigmoid(x):
    return torch.sigmoid(x)
def _layernorm(x, axis=-1, eps=1e-5):
    m = x.mean(dim=axis, keepdim=True)
    v = x.var(dim=axis, keepdim=True, unbiased=False)
    return (x - m) / torch.sqrt(v + eps)
def _scatter_add(tgt, idx, src, axis=0):
    return tgt.clone().index_add_(axis, idx, src)
def _segment_sum(src, seg, n):
    out = torch.zeros((n,) + src.shape[1:], dtype=src.dtype)
    return out.index_add_(0, seg, src)
def _pad(x, pw):
    flat = tuple(v for pair in reversed(pw) for v in pair)
    return torch.nn.functional.pad(x, flat)

kernel_name = 'recurrent_scan__compressed_kv_cla__geglu_ffn__decode'

def setup_inputs():

    _w = (lambda a: (lambda t: t.to(torch.bfloat16) if t.is_floating_point() else t)(torch.as_tensor(a)))
    def _A_setup():
        B, H, Sq, Sk, D, M = 2, 32, 1, 4096, 128, 576
        Dc = 4 * D
        return {
            "x": _w((lambda *s: torch.randn(*s, dtype=torch.bfloat16) * 0.05)(B, Sq, M)),
            "c_kv": _w((lambda *s: torch.randn(*s, dtype=torch.bfloat16) * 0.2)(B, Sk, Dc)),
            "w_q": _w((lambda *s: torch.randn(*s, dtype=torch.bfloat16) * 3.2)(M, H, D) * (M ** -0.5)),
            "w_uk": _w((lambda *s: torch.randn(*s, dtype=torch.bfloat16) * 3.2)(Dc, H, D) * (Dc ** -0.5)),
            "w_uv": _w((lambda *s: torch.randn(*s, dtype=torch.bfloat16) * 0.2)(Dc, H, D) * (Dc ** -0.5)),
            "w_o": _w((lambda *s: torch.randn(*s, dtype=torch.bfloat16) * 0.2)(H, D, M) * ((H * D) ** -0.5)),
        }
    _A_in = _A_setup()

    def _B_setup():
        B, S, D, F = 2, 1, 576, 4608
        return {
            "x": _w((lambda *s: torch.randn(*s, dtype=torch.bfloat16) * 0.05)(B, S, D)),
            "w_gate": _w((lambda *s: torch.randn(*s, dtype=torch.bfloat16) * 0.1)(D, F)),
            "w_up": _w((lambda *s: torch.randn(*s, dtype=torch.bfloat16) * 0.1)(D, F)),
            "w_down": _w((lambda *s: torch.randn(*s, dtype=torch.bfloat16) * 0.1)(F, D)),
        }
    _B_in = _B_setup()

    return {
        "A_x": _A_in["x"],
        "A_c_kv": _A_in["c_kv"],
        "A_w_q": _A_in["w_q"],
        "A_w_uk": _A_in["w_uk"],
        "A_w_uv": _A_in["w_uv"],
        "A_w_o": _A_in["w_o"],
        "B_x": _B_in["x"],
        "B_w_gate": _B_in["w_gate"],
        "B_w_up": _B_in["w_up"],
        "B_w_down": _B_in["w_down"],
    }

def reference(A_x, A_c_kv, A_w_q, A_w_uk, A_w_uv, A_w_o, B_x, B_w_gate, B_w_up, B_w_down):
    def _A_ref(x, c_kv, w_q, w_uk, w_uv, w_o):
        B, Sq, M = x.shape[0], x.shape[1], x.shape[2]
        Sk = c_kv.shape[1]
        H, D = w_q.shape[1], w_q.shape[2]
        q = torch.einsum("bqm,mhd->bhqd", x, w_q)
        k = torch.einsum("bkc,chd->bhkd", c_kv, w_uk)
        v = torch.einsum("bkc,chd->bhkd", c_kv, w_uv)
        scores = torch.einsum("bhqd,bhkd->bhqk", q, k) * (D ** -0.5)
        off = Sk - Sq
        qi = torch.arange(Sq)[:, None]
        kj = torch.arange(Sk)[None, :]
        cmask = kj <= (qi + off)
        scores = torch.where(cmask[None, None], scores, -1e9)
        p = _softmax(scores, axis=-1)
        ctx = torch.einsum("bhqk,bhkd->bhqd", p, v)
        return torch.einsum("bhqd,hdm->bqm", ctx, w_o)

    def _B_ref(x, w_gate, w_up, w_down):
        return (_gelu(x @ w_gate) * (x @ w_up)) @ w_down

    x = A_x
    xn = _layernorm(x, axis=-1)
    s = _A_ref(xn, A_c_kv, A_w_q, A_w_uk, A_w_uv, A_w_o)
    g = _silu(_B_ref(xn, B_w_gate, B_w_up, B_w_down))
    return x + s * g
```

```asm
; @launch grid=(256,1,1) block=(512,1,1) lds=163840
.amdgcn_target "amdgcn-amd-amdhsa--gfx950"
.text
.globl recurrent_scan__compressed_kv_cla__geglu_ffn__decode_kernel
.p2align 8
.type recurrent_scan__compressed_kv_cla__geglu_ffn__decode_kernel,@function
recurrent_scan__compressed_kv_cla__geglu_ffn__decode_kernel:
    s_cmp_ge_u32 s2, 256
    s_cbranch_scc1 L_end
    s_load_dwordx16 s[8:23], s[0:1], 0
    v_lshrrev_b32 v2, 6, v0
    v_and_b32 v1, 63, v0
    s_getpc_b64 s[4:5]
L_pc0:
    s_and_b32 s64, s2, 24
    v_add_u32 v4, s64, v2
    v_min_u32 v5, 4, v1
    v_mad_u32_u24 v4, v4, 5, v5
    v_lshlrev_b32 v4, 7, v4
    v_min_u32 v4, L_end-L_pc0, v4
    global_load_dword v195, v4, s[4:5]
    s_load_dwordx8 s[24:31], s[0:1], 64
    s_load_dwordx2 s[32:33], s[0:1], 96
    v_readfirstlane_b32 s35, v2
    v_lshrrev_b32 v2, 4, v1
    v_and_b32 v3, 15, v1
    s_and_b32 s36, s2, 7
    s_lshr_b32 s37, s2, 3
    s_setprio 2
    v_mov_b32 v5, 0
    v_mov_b32 v29, 0
    s_cmp_eq_u32 s35, 0
    s_cbranch_scc1 L_q1
    s_barrier
    s_branch L_noq1
L_q1:
    v_lshrrev_b32 v4, 3, v3
    v_mul_u32_u24 v4, 1152, v4
    v_and_b32 v6, 7, v3
    v_lshl_add_u32 v6, v2, 3, v6
    v_lshl_add_u32 v5, v6, 4, v4
    v_lshl_add_u32 v6, v6, 2, v4
    s_and_b32 s70, s2, 31
    s_lshr_b32 s71, s2, 5
    s_mul_i32 s65, s71, 72
    v_mad_u32_u24 v7, v2, 18, s65
    v_lshl_add_u32 v7, v7, 1, v4
    v_lshrrev_b32 v20, 1, v2
    v_mad_u32_u24 v20, v20, 18, s65
    v_and_b32 v21, 1, v2
    v_add_u32 v20, v20, v21
    s_lshl_b32 s64, s70, 8
    v_lshlrev_b32 v20, 13, v20
    v_lshl_add_u32 v20, v3, 4, v20
    v_add_u32 v20, s64, v20
    v_add_u32 v21, 294912, v20
    s_movk_i32 s64, 0x4000
    v_mov_b32 v251, 160256
    v_mov_b32 v27, 0
    v_lshl_add_u32 v26, v3, 2, v251
    ds_write_b32 v26, v27
    s_waitcnt lgkmcnt(0)
    global_load_dwordx4 v[8:11], v5, s[8:9]
    global_load_dwordx4 v[12:15], v5, s[8:9] offset:512
    global_load_dword v16, v6, s[8:9] offset:1024
    global_load_dwordx4 v[104:107], v7, s[8:9]
    global_load_dwordx4 v[108:111], v7, s[8:9] offset:16
    global_load_dword v112, v7, s[8:9] offset:32
    global_load_dwordx4 v[32:35], v20, s[12:13] nt
    v_add_u32 v20, s64, v20
    global_load_dwordx4 v[36:39], v21, s[12:13] nt
    v_add_u32 v21, s64, v21
    global_load_dwordx4 v[40:43], v20, s[12:13] nt
    v_add_u32 v20, s64, v20
    global_load_dwordx4 v[44:47], v21, s[12:13] nt
    v_add_u32 v21, s64, v21
    global_load_dwordx4 v[48:51], v20, s[12:13] nt
    v_add_u32 v20, s64, v20
    global_load_dwordx4 v[52:55], v21, s[12:13] nt
    v_add_u32 v21, s64, v21
    global_load_dwordx4 v[56:59], v20, s[12:13] nt
    v_add_u32 v20, s64, v20
    global_load_dwordx4 v[60:63], v21, s[12:13] nt
    v_add_u32 v21, s64, v21
    global_load_dwordx4 v[64:67], v20, s[12:13] nt
    v_add_u32 v20, s64, v20
    global_load_dwordx4 v[68:71], v21, s[12:13] nt
    v_add_u32 v21, s64, v21
    global_load_dwordx4 v[72:75], v20, s[12:13] nt
    v_add_u32 v20, s64, v20
    global_load_dwordx4 v[76:79], v21, s[12:13] nt
    v_add_u32 v21, s64, v21
    global_load_dwordx4 v[80:83], v20, s[12:13] nt
    v_add_u32 v20, s64, v20
    global_load_dwordx4 v[84:87], v21, s[12:13] nt
    v_add_u32 v21, s64, v21
    global_load_dwordx4 v[88:91], v20, s[12:13] nt
    v_add_u32 v20, s64, v20
    global_load_dwordx4 v[92:95], v21, s[12:13] nt
    v_add_u32 v21, s64, v21
    global_load_dwordx4 v[96:99], v20, s[12:13] nt
    global_load_dwordx4 v[100:103], v21, s[12:13] nt
    s_barrier
    s_load_dword s34, s[32:33], 0
    s_mov_b32 s40, s32
    s_mov_b32 s41, s33
    s_mov_b32 s42, 268435456
    s_mov_b32 s43, 0x20000
    v_and_b32 v28, 4, v3
    v_cmp_eq_u32 vcc, 0, v28
    v_mov_b32 v28, 0xffff
    s_nop 0
    v_cndmask_b32 v244, 0, v28, vcc
    v_xor_b32 v245, v244, v28
    v_lshlrev_b32 v246, 16, v244
    v_lshlrev_b32 v247, 16, v245
    v_and_b32 v248, 3, v3
    v_mul_u32_u24 v248, 0x5555, v248
    s_and_b32 s64, s71, 3
    s_lshr_b32 s65, s71, 2
    s_lshl_b32 s65, s65, 3
    s_or_b32 s64, s64, s65
    s_lshl_b32 s64, s64, 9
    s_lshl_b32 s65, s70, 13
    s_add_u32 s64, s64, s65
    s_add_u32 s72, s64, 3407872
    v_mov_b32 v238, 0x05040100
    v_mov_b32 v239, 0x07060302
    v_lshrrev_b32 v5, 5, v1
    v_lshlrev_b32 v5, 11, v5
    v_lshl_add_u32 v5, v3, 5, v5
    v_and_b32 v4, 1, v2
    v_lshl_add_u32 v5, v4, 4, v5
    v_lshlrev_b32 v4, 3, v1
    v_add_u32 v4, 160768, v4
    v_mov_b32 v232, 0
    v_mov_b32 v233, 0
    v_mov_b32 v234, 0
    v_mov_b32 v235, 0
    s_waitcnt vmcnt(21)
    v_mov_b32 v28, 0
    v_mov_b32 v29, 0
    s_mov_b32 s64, 0x3f803f80
    v_dot2c_f32_bf16 v28, s64, v8
    v_dot2c_f32_bf16 v29, v8, v8
    v_dot2c_f32_bf16 v28, s64, v9
    v_dot2c_f32_bf16 v29, v9, v9
    v_dot2c_f32_bf16 v28, s64, v10
    v_dot2c_f32_bf16 v29, v10, v10
    v_dot2c_f32_bf16 v28, s64, v11
    v_dot2c_f32_bf16 v29, v11, v11
    v_dot2c_f32_bf16 v28, s64, v12
    v_dot2c_f32_bf16 v29, v12, v12
    v_dot2c_f32_bf16 v28, s64, v13
    v_dot2c_f32_bf16 v29, v13, v13
    v_dot2c_f32_bf16 v28, s64, v14
    v_dot2c_f32_bf16 v29, v14, v14
    v_dot2c_f32_bf16 v28, s64, v15
    v_dot2c_f32_bf16 v29, v15, v15
    v_dot2c_f32_bf16 v28, s64, v16
    v_dot2c_f32_bf16 v29, v16, v16
    s_nop 1
    v_add_f32_dpp v28, v28, v28 quad_perm:[1,0,3,2] row_mask:0xf bank_mask:0xf
    v_add_f32_dpp v29, v29, v29 quad_perm:[1,0,3,2] row_mask:0xf bank_mask:0xf
    s_nop 0
    v_add_f32_dpp v28, v28, v28 quad_perm:[2,3,0,1] row_mask:0xf bank_mask:0xf
    v_add_f32_dpp v29, v29, v29 quad_perm:[2,3,0,1] row_mask:0xf bank_mask:0xf
    s_nop 0
    v_add_f32_dpp v28, v28, v28 row_half_mirror row_mask:0xf bank_mask:0xf
    v_add_f32_dpp v29, v29, v29 row_half_mirror row_mask:0xf bank_mask:0xf
    s_nop 1
    v_permlane16_swap_b32 v28, v29
    v_add_f32 v28, v28, v29
    v_mov_b32 v29, v28
    s_nop 1
    v_permlane32_swap_b32 v28, v29
    v_add_f32 v28, v28, v29
    v_mul_f32 v28, 0x3ae38e39, v28
    v_mov_b32 v29, v28
    s_nop 1
    v_permlane16_swap_b32 v28, v29
    v_fma_f32 v29, -v28, v28, v29
    v_max_f32 v29, 0, v29
    v_cvt_pk_bf16_f32 v30, v28, v29
    v_lshlrev_b32 v249, 16, v30
    v_and_b32 v29, 0xffff0000, v30
    v_add_f32 v29, 0x3727c5ac, v29
    v_cvt_pk_bf16_f32 v29, v29, v29
    v_lshlrev_b32 v29, 16, v29
    v_sqrt_f32 v29, v29
    s_nop 0
    v_cvt_pk_bf16_f32 v29, v29, v29
    v_lshlrev_b32 v29, 16, v29
    v_rcp_f32 v250, v29
    s_nop 0
    ds_write2_b32 v4, v249, v250 offset1:1
    v_mov_b32 v31, 1
    s_mov_b64 exec, 1
    ds_add_u32 v251, v31 offset:0
    s_mov_b64 exec, -1
    s_waitcnt vmcnt(18)
    v_lshlrev_b32 v26, 16, v104
    v_and_b32 v27, 0xffff0000, v104
    v_sub_f32 v26, v26, v249
    v_sub_f32 v27, v27, v249
    v_cvt_pk_bf16_f32 v104, v26, v27
    v_lshlrev_b32 v26, 16, v104
    v_and_b32 v27, 0xffff0000, v104
    v_mul_f32 v26, v26, v250
    v_mul_f32 v27, v27, v250
    v_cvt_pk_bf16_f32 v104, v26, v27
    v_and_b32 v116, v104, v244
    v_and_b32 v117, v104, v245
    v_and_b32 v118, v104, v246
    v_and_b32 v119, v104, v247
    v_lshlrev_b32 v26, 16, v105
    v_and_b32 v27, 0xffff0000, v105
    v_sub_f32 v26, v26, v249
    v_sub_f32 v27, v27, v249
    v_cvt_pk_bf16_f32 v105, v26, v27
    v_lshlrev_b32 v26, 16, v105
    v_and_b32 v27, 0xffff0000, v105
    v_mul_f32 v26, v26, v250
    v_mul_f32 v27, v27, v250
    v_cvt_pk_bf16_f32 v105, v26, v27
    v_and_b32 v120, v105, v244
    v_and_b32 v121, v105, v245
    v_and_b32 v122, v105, v246
    v_and_b32 v123, v105, v247
    v_lshlrev_b32 v26, 16, v106
    v_and_b32 v27, 0xffff0000, v106
    v_sub_f32 v26, v26, v249
    v_sub_f32 v27, v27, v249
    v_cvt_pk_bf16_f32 v106, v26, v27
    v_lshlrev_b32 v26, 16, v106
    v_and_b32 v27, 0xffff0000, v106
    v_mul_f32 v26, v26, v250
    v_mul_f32 v27, v27, v250
    v_cvt_pk_bf16_f32 v106, v26, v27
    v_and_b32 v124, v106, v244
    v_and_b32 v125, v106, v245
    v_and_b32 v126, v106, v246
    v_and_b32 v127, v106, v247
    v_lshlrev_b32 v26, 16, v107
    v_and_b32 v27, 0xffff0000, v107
    v_sub_f32 v26, v26, v249
    v_sub_f32 v27, v27, v249
    v_cvt_pk_bf16_f32 v107, v26, v27
    v_lshlrev_b32 v26, 16, v107
    v_and_b32 v27, 0xffff0000, v107
    v_mul_f32 v26, v26, v250
    v_mul_f32 v27, v27, v250
    v_cvt_pk_bf16_f32 v107, v26, v27
    v_and_b32 v128, v107, v244
    v_and_b32 v129, v107, v245
    v_and_b32 v130, v107, v246
    v_and_b32 v131, v107, v247
    v_lshlrev_b32 v26, 16, v108
    v_and_b32 v27, 0xffff0000, v108
    v_sub_f32 v26, v26, v249
    v_sub_f32 v27, v27, v249
    v_cvt_pk_bf16_f32 v108, v26, v27
    v_lshlrev_b32 v26, 16, v108
    v_and_b32 v27, 0xffff0000, v108
    v_mul_f32 v26, v26, v250
    v_mul_f32 v27, v27, v250
    v_cvt_pk_bf16_f32 v108, v26, v27
    v_and_b32 v132, v108, v244
    v_and_b32 v133, v108, v245
    v_and_b32 v134, v108, v246
    v_and_b32 v135, v108, v247
    v_lshlrev_b32 v26, 16, v109
    v_and_b32 v27, 0xffff0000, v109
    v_sub_f32 v26, v26, v249
    v_sub_f32 v27, v27, v249
    v_cvt_pk_bf16_f32 v109, v26, v27
    v_lshlrev_b32 v26, 16, v109
    v_and_b32 v27, 0xffff0000, v109
    v_mul_f32 v26, v26, v250
    v_mul_f32 v27, v27, v250
    v_cvt_pk_bf16_f32 v109, v26, v27
    v_and_b32 v136, v109, v244
    v_and_b32 v137, v109, v245
    v_and_b32 v138, v109, v246
    v_and_b32 v139, v109, v247
    v_lshlrev_b32 v26, 16, v110
    v_and_b32 v27, 0xffff0000, v110
    v_sub_f32 v26, v26, v249
    v_sub_f32 v27, v27, v249
    v_cvt_pk_bf16_f32 v110, v26, v27
    v_lshlrev_b32 v26, 16, v110
    v_and_b32 v27, 0xffff0000, v110
    v_mul_f32 v26, v26, v250
    v_mul_f32 v27, v27, v250
    v_cvt_pk_bf16_f32 v110, v26, v27
    v_and_b32 v140, v110, v244
    v_and_b32 v141, v110, v245
    v_and_b32 v142, v110, v246
    v_and_b32 v143, v110, v247
    v_lshlrev_b32 v26, 16, v111
    v_and_b32 v27, 0xffff0000, v111
    v_sub_f32 v26, v26, v249
    v_sub_f32 v27, v27, v249
    v_cvt_pk_bf16_f32 v111, v26, v27
    v_lshlrev_b32 v26, 16, v111
    v_and_b32 v27, 0xffff0000, v111
    v_mul_f32 v26, v26, v250
    v_mul_f32 v27, v27, v250
    v_cvt_pk_bf16_f32 v111, v26, v27
    v_and_b32 v144, v111, v244
    v_and_b32 v145, v111, v245
    v_and_b32 v146, v111, v246
    v_and_b32 v147, v111, v247
    v_lshlrev_b32 v26, 16, v112
    v_and_b32 v27, 0xffff0000, v112
    v_sub_f32 v26, v26, v249
    v_sub_f32 v27, v27, v249
    v_cvt_pk_bf16_f32 v112, v26, v27
    v_lshlrev_b32 v26, 16, v112
    v_and_b32 v27, 0xffff0000, v112
    v_mul_f32 v26, v26, v250
    v_mul_f32 v27, v27, v250
    v_cvt_pk_bf16_f32 v112, v26, v27
    v_and_b32 v148, v112, v244
    v_and_b32 v149, v112, v245
    v_and_b32 v150, v112, v246
    v_and_b32 v151, v112, v247
    s_waitcnt lgkmcnt(0)
    s_add_u32 s60, s34, 0x9E3779B9
    s_mul_i32 s61, s60, 0x85EBCA6B
    s_not_b32 s62, s60
    s_xor_b32 s63, s60, 0x5A5AA5A5
    s_waitcnt vmcnt(16)
    v_smfmac_f32_16x16x64_bf16 v[232:235], v[116:119], v[32:39], v248
    s_waitcnt vmcnt(14)
    v_smfmac_f32_16x16x64_bf16 v[232:235], v[120:123], v[40:47], v248
    s_waitcnt vmcnt(12)
    v_smfmac_f32_16x16x64_bf16 v[232:235], v[124:127], v[48:55], v248
    s_waitcnt vmcnt(10)
    v_smfmac_f32_16x16x64_bf16 v[232:235], v[128:131], v[56:63], v248
    s_waitcnt vmcnt(8)
    v_smfmac_f32_16x16x64_bf16 v[232:235], v[132:135], v[64:71], v248
    s_waitcnt vmcnt(6)
    v_smfmac_f32_16x16x64_bf16 v[232:235], v[136:139], v[72:79], v248
    s_waitcnt vmcnt(4)
    v_smfmac_f32_16x16x64_bf16 v[232:235], v[140:143], v[80:87], v248
    s_waitcnt vmcnt(2)
    v_smfmac_f32_16x16x64_bf16 v[232:235], v[144:147], v[88:95], v248
    s_waitcnt vmcnt(0)
    v_smfmac_f32_16x16x64_bf16 v[232:235], v[148:151], v[96:103], v248
    s_nop 7
    v_cvt_pk_bf16_f32 v8, v232, v233
    v_cvt_pk_bf16_f32 v9, v234, v235
    v_perm_b32 v12, v8, s60, v238
    v_perm_b32 v13, v8, s60, v239
    v_perm_b32 v14, v9, s61, v238
    v_perm_b32 v15, v9, s61, v239
    buffer_store_dwordx4 v[12:15], v5, s[40:43], s72 offen sc1
    v_mov_b32 v31, 1
    s_mov_b64 exec, 1
    ds_add_u32 v251, v31 offset:0
    s_mov_b64 exec, -1
    s_cmp_ge_u32 s37, 24
    s_cbranch_scc1 L_F_go
    s_cmp_ge_u32 s37, 8
    s_cbranch_scc1 L_A_go
    s_lshr_b32 s38, s37, 1
    s_lshl_b32 s64, s36, 2
    s_add_u32 s38, s38, s64
    s_and_b32 s39, s37, 1
    s_lshl_b32 s56, s38, 8
    s_lshl_b32 s58, s38, 10
    s_lshl_b32 s64, s39, 9
    s_add_u32 s58, s58, s64
L_q2:
    s_lshl_b32 s64, s35, 14
    s_add_u32 s64, s64, 65536
    v_lshl_add_u32 v24, v3, 8, s64
    v_xor_b32 v21, v3, v2
    v_lshl_add_u32 v24, v21, 4, v24
    v_xor_b32 v25, 64, v24
    v_xor_b32 v26, 128, v24
    v_xor_b32 v27, 192, v24
    v_mul_u32_u24 v7, 288, v3
    v_lshl_add_u32 v7, v2, 4, v7
    v_add_u32 v7, 147456, v7
    v_bfe_u32 v22, v3, 2, 1
    v_lshlrev_b32 v22, 15, v22
    v_lshrrev_b32 v23, 3, v3
    v_lshl_add_u32 v22, v23, 5, v22
    v_lshl_add_u32 v22, v2, 3, v22
    v_and_b32 v23, 1, v3
    v_lshl_add_u32 v22, v23, 6, v22
    s_lshl_b32 s65, s35, 7
    s_add_u32 s64, s58, s65
    s_add_u32 s73, s64, 131072
    v_cmp_lt_u32 s[68:69], 7, v3
    v_lshrrev_b32 v4, 5, v1
    v_lshl_add_u32 v4, v4, 2, s35
    v_and_b32 v5, 31, v1
    v_mul_u32_u24 v6, 288, v4
    v_lshl_add_u32 v6, v5, 3, v6
    v_add_u32 v6, 147456, v6
    v_lshlrev_b32 v4, 9, v4
    v_lshl_add_u32 v4, v5, 4, v4
    s_lshl_b32 s72, s38, 13
    s_add_u32 s72, s72, 3407872
    s_add_u32 s75, s72, 4096
    s_mov_b32 s67, 16777216
L_hold_4:
    ds_read_b32 v31, v251 offset:4
    s_sub_u32 s67, s67, 1
    s_cmp_eq_u32 s67, 0
    s_cbranch_scc1 L_holdd_5
    s_sleep 2
    s_waitcnt lgkmcnt(0)
    v_cmp_gt_u32 vcc, 4, v31
    s_cbranch_vccnz L_hold_4
L_holdd_5:
    s_waitcnt lgkmcnt(0)
    buffer_load_dwordx4 v[12:15], v4, s[40:43], s72 offen sc1
    buffer_load_dwordx4 v[16:19], v4, s[40:43], s75 offen sc1
    v_mov_b32 v31, 1
    s_mov_b64 exec, 1
    ds_add_u32 v251, v31 offset:16
    s_mov_b64 exec, -1
    s_mov_b32 s67, 16777216
L_hold_6:
    ds_read_b32 v31, v251 offset:40
    s_sub_u32 s67, s67, 1
    s_cmp_eq_u32 s67, 0
    s_cbranch_scc1 L_holdd_7
    s_waitcnt lgkmcnt(0)
    v_cmp_gt_u32 vcc, 4, v31
    s_cbranch_vccnz L_hold_6
L_holdd_7:
    s_waitcnt lgkmcnt(0)
    ds_read_b128 v[32:35], v24 offset:0
    ds_read_b128 v[36:39], v25 offset:0
    ds_read_b128 v[40:43], v26 offset:0
    ds_read_b128 v[44:47], v27 offset:0
    ds_read_b128 v[48:51], v24 offset:4096
    ds_read_b128 v[52:55], v25 offset:4096
    ds_read_b128 v[56:59], v26 offset:4096
    ds_read_b128 v[60:63], v27 offset:4096
    ds_read_b128 v[64:67], v24 offset:8192
    ds_read_b128 v[68:71], v25 offset:8192
    ds_read_b128 v[72:75], v26 offset:8192
    ds_read_b128 v[76:79], v27 offset:8192
    ds_read_b128 v[80:83], v24 offset:12288
    ds_read_b128 v[84:87], v25 offset:12288
    ds_read_b128 v[88:91], v26 offset:12288
    ds_read_b128 v[92:95], v27 offset:12288
    s_mov_b32 s66, 2097152
    s_branch L_qpf_3
L_qp_1:
    s_sleep 4
    buffer_load_dwordx4 v[12:15], v4, s[40:43], s72 offen sc1
    buffer_load_dwordx4 v[16:19], v4, s[40:43], s75 offen sc1
L_qpf_3:
    s_sub_u32 s66, s66, 1
    s_cmp_eq_u32 s66, 0
    s_waitcnt vmcnt(1)
    v_perm_b32 v28, v13, v12, v238
    v_perm_b32 v29, v15, v14, v238
    v_perm_b32 v8, v13, v12, v239
    v_perm_b32 v9, v15, v14, v239
    v_xor_b32 v28, s60, v28
    v_xor_b32 v29, s61, v29
    s_waitcnt vmcnt(0)
    s_cbranch_scc1 L_qpd_2
    v_perm_b32 v30, v17, v16, v238
    v_perm_b32 v31, v19, v18, v238
    v_xor_b32 v30, s60, v30
    v_xor_b32 v31, s61, v31
    v_or3_b32 v28, v28, v29, v30
    v_or_b32 v28, v28, v31
    v_cmp_ne_u32 vcc, 0, v28
    s_cbranch_vccnz L_qp_1
L_qpd_2:
    ds_write_b64 v6, v[8:9]
    v_perm_b32 v10, v17, v16, v239
    v_perm_b32 v11, v19, v18, v239
    ds_write_b64 v6, v[10:11] offset:2304
    v_mov_b32 v31, 1
    s_mov_b64 exec, 1
    ds_add_u32 v251, v31 offset:8
    s_mov_b64 exec, -1
    s_mov_b32 s67, 16777216
L_hold_8:
    ds_read_b32 v31, v251 offset:8
    s_sub_u32 s67, s67, 1
    s_cmp_eq_u32 s67, 0
    s_cbranch_scc1 L_holdd_9
    s_waitcnt lgkmcnt(0)
    v_cmp_gt_u32 vcc, 4, v31
    s_cbranch_vccnz L_hold_8
L_holdd_9:
    s_waitcnt lgkmcnt(0)
    ds_read_b128 v[96:99], v7 offset:0
    ds_read_b128 v[100:103], v7 offset:64
    ds_read_b128 v[104:107], v7 offset:128
    ds_read_b128 v[108:111], v7 offset:192
    s_mov_b64 vcc, s[68:69]
    s_waitcnt lgkmcnt(3)
    v_mfma_f32_16x16x32_bf16 v[112:115], v[32:35], v[96:99], 0
    v_mfma_f32_16x16x32_bf16 v[116:119], v[48:51], v[96:99], 0
    v_mfma_f32_16x16x32_bf16 v[120:123], v[64:67], v[96:99], 0
    v_mfma_f32_16x16x32_bf16 v[124:127], v[80:83], v[96:99], 0
    s_waitcnt lgkmcnt(2)
    v_mfma_f32_16x16x32_bf16 v[112:115], v[36:39], v[100:103], v[112:115]
    v_mfma_f32_16x16x32_bf16 v[116:119], v[52:55], v[100:103], v[116:119]
    v_mfma_f32_16x16x32_bf16 v[120:123], v[68:71], v[100:103], v[120:123]
    v_mfma_f32_16x16x32_bf16 v[124:127], v[84:87], v[100:103], v[124:127]
    s_waitcnt lgkmcnt(1)
    v_mfma_f32_16x16x32_bf16 v[112:115], v[40:43], v[104:107], v[112:115]
    v_mfma_f32_16x16x32_bf16 v[116:119], v[56:59], v[104:107], v[116:119]
    v_mfma_f32_16x16x32_bf16 v[120:123], v[72:75], v[104:107], v[120:123]
    v_mfma_f32_16x16x32_bf16 v[124:127], v[88:91], v[104:107], v[124:127]
    s_waitcnt lgkmcnt(0)
    v_mfma_f32_16x16x32_bf16 v[112:115], v[44:47], v[108:111], v[112:115]
    v_mfma_f32_16x16x32_bf16 v[116:119], v[60:63], v[108:111], v[116:119]
    v_mfma_f32_16x16x32_bf16 v[120:123], v[76:79], v[108:111], v[120:123]
    v_mfma_f32_16x16x32_bf16 v[124:127], v[92:95], v[108:111], v[124:127]
    s_nop 5
    v_cndmask_b32 v8, v116, v112, vcc
    v_cndmask_b32 v9, v117, v113, vcc
    v_cndmask_b32 v10, v118, v114, vcc
    v_cndmask_b32 v11, v119, v115, vcc
    v_cndmask_b32 v112, v112, v116, vcc
    v_cndmask_b32 v113, v113, v117, vcc
    v_cndmask_b32 v114, v114, v118, vcc
    v_cndmask_b32 v115, v115, v119, vcc
    v_add_f32_dpp v112, v8, v112 row_ror:8 row_mask:0xf bank_mask:0xf
    v_add_f32_dpp v113, v9, v113 row_ror:8 row_mask:0xf bank_mask:0xf
    v_add_f32_dpp v114, v10, v114 row_ror:8 row_mask:0xf bank_mask:0xf
    v_add_f32_dpp v115, v11, v115 row_ror:8 row_mask:0xf bank_mask:0xf
    v_add_f32_dpp v112, v112, v112 quad_perm:[1,0,3,2] row_mask:0xf bank_mask:0xf
    v_add_f32_dpp v113, v113, v113 quad_perm:[1,0,3,2] row_mask:0xf bank_mask:0xf
    v_add_f32_dpp v114, v114, v114 quad_perm:[1,0,3,2] row_mask:0xf bank_mask:0xf
    v_add_f32_dpp v115, v115, v115 quad_perm:[1,0,3,2] row_mask:0xf bank_mask:0xf
    v_add_f32_dpp v112, v112, v112 quad_perm:[2,3,0,1] row_mask:0xf bank_mask:0xf
    v_add_f32_dpp v113, v113, v113 quad_perm:[2,3,0,1] row_mask:0xf bank_mask:0xf
    v_add_f32_dpp v114, v114, v114 quad_perm:[2,3,0,1] row_mask:0xf bank_mask:0xf
    v_add_f32_dpp v115, v115, v115 quad_perm:[2,3,0,1] row_mask:0xf bank_mask:0xf
    v_cvt_pk_bf16_f32 v12, v112, v113
    v_cvt_pk_bf16_f32 v13, v114, v115
    v_cndmask_b32 v8, v124, v120, vcc
    v_cndmask_b32 v9, v125, v121, vcc
    v_cndmask_b32 v10, v126, v122, vcc
    v_cndmask_b32 v11, v127, v123, vcc
    v_cndmask_b32 v120, v120, v124, vcc
    v_cndmask_b32 v121, v121, v125, vcc
    v_cndmask_b32 v122, v122, v126, vcc
    v_cndmask_b32 v123, v123, v127, vcc
    v_add_f32_dpp v120, v8, v120 row_ror:8 row_mask:0xf bank_mask:0xf
    v_add_f32_dpp v121, v9, v121 row_ror:8 row_mask:0xf bank_mask:0xf
    v_add_f32_dpp v122, v10, v122 row_ror:8 row_mask:0xf bank_mask:0xf
    v_add_f32_dpp v123, v11, v123 row_ror:8 row_mask:0xf bank_mask:0xf
    v_add_f32_dpp v120, v120, v120 quad_perm:[1,0,3,2] row_mask:0xf bank_mask:0xf
    v_add_f32_dpp v121, v121, v121 quad_perm:[1,0,3,2] row_mask:0xf bank_mask:0xf
    v_add_f32_dpp v122, v122, v122 quad_perm:[1,0,3,2] row_mask:0xf bank_mask:0xf
    v_add_f32_dpp v123, v123, v123 quad_perm:[1,0,3,2] row_mask:0xf bank_mask:0xf
    v_add_f32_dpp v120, v120, v120 quad_perm:[2,3,0,1] row_mask:0xf bank_mask:0xf
    v_add_f32_dpp v121, v121, v121 quad_perm:[2,3,0,1] row_mask:0xf bank_mask:0xf
    v_add_f32_dpp v122, v122, v122 quad_perm:[2,3,0,1] row_mask:0xf bank_mask:0xf
    v_add_f32_dpp v123, v123, v123 quad_perm:[2,3,0,1] row_mask:0xf bank_mask:0xf
    v_cvt_pk_bf16_f32 v14, v120, v121
    v_cvt_pk_bf16_f32 v15, v122, v123
    s_mov_b32 vcc_lo, 0x22222222
    s_mov_b32 vcc_hi, 0x22222222
    s_mov_b32 exec_lo, 0x33333333
    s_mov_b32 exec_hi, 0x33333333
    v_cndmask_b32 v12, v12, v14, vcc
    v_cndmask_b32 v13, v13, v15, vcc
    buffer_store_dwordx2 v[12:13], v22, s[40:43], s73 offen sc1
    s_mov_b64 exec, -1
    v_mov_b32 v31, 1
    s_mov_b64 exec, 1
    ds_add_u32 v251, v31 offset:12
    s_mov_b64 exec, -1
    s_mov_b32 s67, 16777216
L_hold_10:
    ds_read_b32 v31, v251 offset:12
    s_sub_u32 s67, s67, 1
    s_cmp_eq_u32 s67, 0
    s_cbranch_scc1 L_holdd_11
    s_waitcnt lgkmcnt(0)
    v_cmp_gt_u32 vcc, 4, v31
    s_cbranch_vccnz L_hold_10
L_holdd_11:
    s_waitcnt lgkmcnt(0)
    s_branch L_roleH
L_noq1:
    s_cmp_lt_u32 s37, 8
    s_cbranch_scc1 L_H_start
    s_cmp_lt_u32 s37, 24
    s_cbranch_scc1 L_roleA
    s_waitcnt lgkmcnt(0)
    s_load_dword s34, s[32:33], 0
    s_mov_b32 s40, s32
    s_mov_b32 s41, s33
    s_mov_b32 s42, 268435456
    s_mov_b32 s43, 0x20000
    v_mov_b32 v252, -1
    v_mov_b32 v253, -1
    v_mov_b32 v254, -1
    v_mov_b32 v255, -1
    v_mov_b32 v251, 160256
    v_and_b32 v28, 4, v3
    v_cmp_eq_u32 vcc, 0, v28
    v_mov_b32 v28, 0xffff
    s_nop 0
    v_cndmask_b32 v244, 0, v28, vcc
    v_xor_b32 v245, v244, v28
    v_lshlrev_b32 v246, 16, v244
    v_lshlrev_b32 v247, 16, v245
    v_and_b32 v248, 3, v3
    v_mul_u32_u24 v248, 0x5555, v248
    v_mov_b32 v238, 0x05040100
    v_mov_b32 v239, 0x07060302
    s_waitcnt lgkmcnt(0)
    s_add_u32 s60, s34, 0x9E3779B9
    s_mul_i32 s61, s60, 0x85EBCA6B
    s_not_b32 s62, s60
    s_xor_b32 s63, s60, 0x5A5AA5A5
    s_sub_u32 s64, s35, 3
    s_cmp_gt_u32 s64, 1
    s_cbranch_scc1 L_pfuk_12
    s_sub_u32 s65, s37, 8
    s_lshr_b32 s66, s65, 3
    s_lshl_b32 s66, s66, 4
    s_and_b32 s65, s65, 7
    s_lshl_b32 s65, s65, 6
    s_add_u32 s65, s65, s66
    s_add_u32 s65, s65, 16
    s_lshl_b32 s64, s64, 3
    s_add_u32 s65, s65, s64
    v_lshrrev_b32 v5, 3, v1
    v_add_u32 v5, s65, v5
    v_and_b32 v6, 7, v1
    s_lshl_b32 s64, s36, 10
    v_lshl_add_u32 v6, v6, 7, s64
    v_lshl_add_u32 v5, v5, 13, v6
    global_load_dword v194, v5, s[14:15]
L_pfuk_12:
    s_branch L_roleF
L_H_start:
    s_lshr_b32 s38, s37, 1
    s_lshl_b32 s64, s36, 2
    s_add_u32 s38, s38, s64
    s_and_b32 s39, s37, 1
    s_lshl_b32 s56, s38, 8
    s_lshl_b32 s58, s38, 10
    s_lshl_b32 s64, s39, 9
    s_add_u32 s58, s58, s64
    s_sub_u32 s65, s35, 4
    s_lshl_b32 s73, s65, 14
    s_add_u32 s73, s73, 65536
    s_lshl_b32 s65, s65, 6
    s_lshl_b32 s64, s39, 8
    s_add_u32 s64, s64, s65
    v_add_u32 v20, s64, v2
    v_lshlrev_b32 v20, 13, v20
    v_xor_b32 v21, v3, v2
    v_lshl_add_u32 v20, v21, 4, v20
    v_xor_b32 v21, 64, v20
    v_xor_b32 v22, 128, v20
    v_xor_b32 v23, 192, v20
    s_mov_b32 s74, 0
    v_lshrrev_b32 v5, 5, v1
    v_lshlrev_b32 v5, 15, v5
    v_and_b32 v4, 31, v1
    v_lshl_add_u32 v4, v4, 4, v5
    s_add_u32 s72, s58, 131072
    s_waitcnt lgkmcnt(0)
    s_load_dword s34, s[32:33], 0
    s_mov_b32 s40, s32
    s_mov_b32 s41, s33
    s_mov_b32 s42, 268435456
    s_mov_b32 s43, 0x20000
    v_mov_b32 v252, -1
    v_mov_b32 v253, -1
    v_mov_b32 v254, -1
    v_mov_b32 v255, -1
    s_cmp_lg_u32 s35, 7
    s_cbranch_scc1 L_clr_13
    buffer_store_dwordx4 v[252:255], v4, s[40:43], s72 offen sc1
L_clr_13:
    v_mov_b32 v251, 160256
    s_add_u32 s52, s14, s56
    s_addc_u32 s53, s15, 0
    s_sub_u32 s54, 4194304, s56
    s_mov_b32 s55, 0x20000
    s_cmp_lt_u32 s35, 4
    s_cbranch_scc1 L_now3_14
    s_mov_b32 m0, s73
    s_add_u32 s73, s73, 1024
    buffer_load_dwordx4 v20, s[52:55], s74 offen nt lds
    s_add_u32 s74, s74, 32768
    s_mov_b32 m0, s73
    s_add_u32 s73, s73, 1024
    buffer_load_dwordx4 v21, s[52:55], s74 offen nt lds
    s_add_u32 s74, s74, 32768
    s_mov_b32 m0, s73
    s_add_u32 s73, s73, 1024
    buffer_load_dwordx4 v22, s[52:55], s74 offen nt lds
    s_add_u32 s74, s74, 32768
    s_mov_b32 m0, s73
    s_add_u32 s73, s73, 1024
    buffer_load_dwordx4 v23, s[52:55], s74 offen nt lds
    s_add_u32 s74, s74, 32768
    s_mov_b32 m0, s73
    s_add_u32 s73, s73, 1024
    buffer_load_dwordx4 v20, s[52:55], s74 offen  lds
    s_add_u32 s74, s74, 32768
    s_mov_b32 m0, s73
    s_add_u32 s73, s73, 1024
    buffer_load_dwordx4 v21, s[52:55], s74 offen  lds
    s_add_u32 s74, s74, 32768
    s_mov_b32 m0, s73
    s_add_u32 s73, s73, 1024
    buffer_load_dwordx4 v22, s[52:55], s74 offen  lds
    s_add_u32 s74, s74, 32768
    s_mov_b32 m0, s73
    s_add_u32 s73, s73, 1024
    buffer_load_dwordx4 v23, s[52:55], s74 offen  lds
    s_add_u32 s74, s74, 32768
L_now3_14:
    v_and_b32 v28, 4, v3
    v_cmp_eq_u32 vcc, 0, v28
    v_mov_b32 v28, 0xffff
    s_nop 0
    v_cndmask_b32 v244, 0, v28, vcc
    v_xor_b32 v245, v244, v28
    v_lshlrev_b32 v246, 16, v244
    v_lshlrev_b32 v247, 16, v245
    v_and_b32 v248, 3, v3
    v_mul_u32_u24 v248, 0x5555, v248
    v_mov_b32 v238, 0x05040100
    v_mov_b32 v239, 0x07060302
    s_waitcnt lgkmcnt(0)
    s_add_u32 s60, s34, 0x9E3779B9
    s_mul_i32 s61, s60, 0x85EBCA6B
    s_not_b32 s62, s60
    s_xor_b32 s63, s60, 0x5A5AA5A5
    s_cmp_lg_u32 s35, 7
    s_cbranch_scc1 L_flg_15
    s_lshl_b32 s65, s36, 3
    s_add_u32 s65, s65, s37
    s_waitcnt vmcnt(8)
    v_mov_b32 v252, s60
    v_mov_b32 v253, s61
    v_mov_b32 v254, s62
    v_mov_b32 v255, s63
    s_lshl_b32 s64, s65, 7
    s_add_u32 s64, s64, 4096
    s_mov_b64 exec, 1
    buffer_store_dwordx4 v[252:255], v1, s[40:43], s64 offen sc1
    s_mov_b64 exec, -1
L_flg_15:
    s_cmp_lt_u32 s35, 4
    s_cbranch_scc1 L_now3_16
    s_mov_b32 s67, 16777216
L_hold_17:
    ds_read_b32 v31, v251 offset:0
    s_sub_u32 s67, s67, 1
    s_cmp_eq_u32 s67, 0
    s_cbranch_scc1 L_holdd_18
    s_sleep 2
    s_waitcnt lgkmcnt(0)
    v_cmp_gt_u32 vcc, 2, v31
    s_cbranch_vccnz L_hold_17
L_holdd_18:
    s_waitcnt lgkmcnt(0)
    s_mov_b32 m0, s73
    s_add_u32 s73, s73, 1024
    buffer_load_dwordx4 v20, s[52:55], s74 offen  lds
    s_add_u32 s74, s74, 32768
    s_mov_b32 m0, s73
    s_add_u32 s73, s73, 1024
    buffer_load_dwordx4 v21, s[52:55], s74 offen  lds
    s_add_u32 s74, s74, 32768
    s_mov_b32 m0, s73
    s_add_u32 s73, s73, 1024
    buffer_load_dwordx4 v22, s[52:55], s74 offen  lds
    s_add_u32 s74, s74, 32768
    s_mov_b32 m0, s73
    s_add_u32 s73, s73, 1024
    buffer_load_dwordx4 v23, s[52:55], s74 offen  lds
    s_add_u32 s74, s74, 32768
    s_mov_b32 m0, s73
    s_add_u32 s73, s73, 1024
    buffer_load_dwordx4 v20, s[52:55], s74 offen  lds
    s_add_u32 s74, s74, 32768
    s_mov_b32 m0, s73
    s_add_u32 s73, s73, 1024
    buffer_load_dwordx4 v21, s[52:55], s74 offen  lds
    s_add_u32 s74, s74, 32768
    s_mov_b32 m0, s73
    s_add_u32 s73, s73, 1024
    buffer_load_dwordx4 v22, s[52:55], s74 offen  lds
    s_add_u32 s74, s74, 32768
    s_mov_b32 m0, s73
    s_add_u32 s73, s73, 1024
    buffer_load_dwordx4 v23, s[52:55], s74 offen  lds
    s_add_u32 s74, s74, 32768
    v_mov_b32 v31, 1
    s_mov_b64 exec, 1
    ds_add_u32 v251, v31 offset:4
    s_mov_b64 exec, -1
L_now3_16:
    s_cmp_lt_u32 s35, 4
    s_cbranch_scc1 L_q2
    s_branch L_roleH
L_roleH:
    s_mul_i32 s57, s2, 4608
    s_add_u32 s57, s57, 327680
    s_mul_i32 s64, s38, 147456
    s_add_u32 s52, s18, s64
    s_addc_u32 s53, s19, 0
    s_mov_b32 s54, 147456
    s_mov_b32 s55, 0x20000
    v_lshlrev_b32 v236, 4, v0
    v_add_u32 v237, 81920, v236
    s_cmp_ge_u32 s35, 4
    s_cbranch_scc1 L_H_gather
    s_setprio 0
    v_lshrrev_b32 v4, 1, v2
    v_lshlrev_b32 v4, 2, v4
    v_and_b32 v5, 1, v2
    v_add_u32 v4, v4, v5
    s_lshl_b32 s64, s35, 5
    v_add_u32 v4, s64, v4
    v_mul_u32_u24 v29, 1152, v4
    v_lshl_add_u32 v29, v3, 4, v29
    s_mul_i32 s70, s39, 18432
    s_xor_b32 s71, s39, 1
    s_mul_i32 s71, s71, 18432
    s_mov_b32 s67, 16777216
L_hold_19:
    ds_read_b32 v31, v251 offset:32
    s_sub_u32 s67, s67, 1
    s_cmp_eq_u32 s67, 0
    s_cbranch_scc1 L_holdd_20
    s_sleep 2
    s_waitcnt lgkmcnt(0)
    v_cmp_gt_u32 vcc, 4, v31
    s_cbranch_vccnz L_hold_19
L_holdd_20:
    s_waitcnt lgkmcnt(0)
    s_add_u32 s64, s70, 0
    buffer_load_dwordx4 v[32:35], v29, s[52:55], s64 offen offset:0
    buffer_load_dwordx4 v[40:43], v29, s[52:55], s64 offen offset:256
    buffer_load_dwordx4 v[48:51], v29, s[52:55], s64 offen offset:512
    buffer_load_dwordx4 v[56:59], v29, s[52:55], s64 offen offset:768
    s_add_u32 s64, s70, 9216
    buffer_load_dwordx4 v[36:39], v29, s[52:55], s64 offen offset:0
    buffer_load_dwordx4 v[44:47], v29, s[52:55], s64 offen offset:256
    buffer_load_dwordx4 v[52:55], v29, s[52:55], s64 offen offset:512
    buffer_load_dwordx4 v[60:63], v29, s[52:55], s64 offen offset:768
    s_add_u32 s64, s70, 2304
    buffer_load_dwordx4 v[64:67], v29, s[52:55], s64 offen offset:0
    buffer_load_dwordx4 v[72:75], v29, s[52:55], s64 offen offset:256
    buffer_load_dwordx4 v[80:83], v29, s[52:55], s64 offen offset:512
    buffer_load_dwordx4 v[88:91], v29, s[52:55], s64 offen offset:768
    s_add_u32 s64, s70, 11520
    buffer_load_dwordx4 v[68:71], v29, s[52:55], s64 offen offset:0
    buffer_load_dwordx4 v[76:79], v29, s[52:55], s64 offen offset:256
    buffer_load_dwordx4 v[84:87], v29, s[52:55], s64 offen offset:512
    buffer_load_dwordx4 v[92:95], v29, s[52:55], s64 offen offset:768
    s_add_u32 s64, s71, 0
    buffer_load_dwordx4 v[96:99], v29, s[52:55], s64 offen offset:0
    buffer_load_dwordx4 v[104:107], v29, s[52:55], s64 offen offset:256
    buffer_load_dwordx4 v[112:115], v29, s[52:55], s64 offen offset:512
    buffer_load_dwordx4 v[120:123], v29, s[52:55], s64 offen offset:768
    v_and_b32 v6, 7, v3
    v_lshlrev_b32 v6, 4, v6
    v_lshl_add_u32 v6, v4, 7, v6
    v_add_u32 v6, 65536, v6
    s_lshl_b32 s64, s39, 11
    v_add_u32 v6, s64, v6
    v_xor_b32 v7, 2048, v6
    v_lshrrev_b32 v8, 2, v3
    v_lshl_add_u32 v9, v2, 3, v8
    v_lshlrev_b32 v9, 8, v9
    v_and_b32 v10, 1, v2
    v_lshlrev_b32 v10, 1, v10
    v_lshl_or_b32 v10, v8, 2, v10
    s_lshl_b32 s64, s35, 2
    s_lshl_b32 s65, s39, 1
    s_or_b32 s64, s64, s65
    v_bfe_u32 v11, v3, 1, 1
    v_or_b32 v11, s64, v11
    v_xor_b32 v10, v10, v11
    v_lshl_add_u32 v9, v10, 4, v9
    v_and_b32 v10, 1, v3
    v_lshl_add_u32 v9, v10, 3, v9
    v_xor_b32 v10, 16, v9
    v_add_u32 v10, 1024, v10
    s_mov_b32 s67, 16777216
L_hold_21:
    ds_read_b32 v31, v251 offset:28
    s_sub_u32 s67, s67, 1
    s_cmp_eq_u32 s67, 0
    s_cbranch_scc1 L_holdd_22
    s_sleep 2
    s_waitcnt lgkmcnt(0)
    v_cmp_gt_u32 vcc, 4, v31
    s_cbranch_vccnz L_hold_21
L_holdd_22:
    s_waitcnt lgkmcnt(0)
    v_xor_b32 v11, 0, v9
    ds_read_b64_tr_b16 v[160:161], v11 offset:0
    ds_read_b64_tr_b16 v[164:165], v11 offset:8192
    ds_read_b64_tr_b16 v[168:169], v11 offset:16384
    ds_read_b64_tr_b16 v[172:173], v11 offset:24576
    ds_read_b64_tr_b16 v[176:177], v11 offset:32768
    ds_read_b64_tr_b16 v[180:181], v11 offset:40960
    ds_read_b64_tr_b16 v[184:185], v11 offset:49152
    ds_read_b64_tr_b16 v[188:189], v11 offset:57344
    v_xor_b32 v11, 0, v10
    ds_read_b64_tr_b16 v[162:163], v11 offset:0
    ds_read_b64_tr_b16 v[166:167], v11 offset:8192
    ds_read_b64_tr_b16 v[170:171], v11 offset:16384
    ds_read_b64_tr_b16 v[174:175], v11 offset:24576
    ds_read_b64_tr_b16 v[178:179], v11 offset:32768
    ds_read_b64_tr_b16 v[182:183], v11 offset:40960
    ds_read_b64_tr_b16 v[186:187], v11 offset:49152
    ds_read_b64_tr_b16 v[190:191], v11 offset:57344
    v_xor_b32 v11, 32, v9
    ds_read_b64_tr_b16 v[192:193], v11 offset:0
    ds_read_b64_tr_b16 v[196:197], v11 offset:8192
    ds_read_b64_tr_b16 v[200:201], v11 offset:16384
    ds_read_b64_tr_b16 v[204:205], v11 offset:24576
    ds_read_b64_tr_b16 v[208:209], v11 offset:32768
    ds_read_b64_tr_b16 v[212:213], v11 offset:40960
    ds_read_b64_tr_b16 v[216:217], v11 offset:49152
    ds_read_b64_tr_b16 v[220:221], v11 offset:57344
    v_xor_b32 v11, 32, v10
    ds_read_b64_tr_b16 v[194:195], v11 offset:0
    ds_read_b64_tr_b16 v[198:199], v11 offset:8192
    ds_read_b64_tr_b16 v[202:203], v11 offset:16384
    ds_read_b64_tr_b16 v[206:207], v11 offset:24576
    ds_read_b64_tr_b16 v[210:211], v11 offset:32768
    ds_read_b64_tr_b16 v[214:215], v11 offset:40960
    ds_read_b64_tr_b16 v[218:219], v11 offset:49152
    ds_read_b64_tr_b16 v[222:223], v11 offset:57344
    s_setprio 2
    v_mov_b32 v31, 1
    s_mov_b64 exec, 1
    ds_add_u32 v251, v31 offset:36
    s_mov_b64 exec, -1
    v_lshrrev_b32 v4, 3, v3
    v_mul_u32_u24 v4, 576, v4
    v_lshl_add_u32 v4, v2, 4, v4
    v_add_u32 v4, 102400, v4
    s_mul_i32 s64, s35, 4608
    s_add_u32 s64, s64, 81920
    v_lshrrev_b32 v5, 5, v1
    v_mul_u32_u24 v5, 2304, v5
    v_lshl_add_u32 v5, v3, 5, v5
    v_and_b32 v9, 1, v2
    v_lshl_add_u32 v5, v9, 4, v5
    v_add_u32 v5, s64, v5
    s_waitcnt vmcnt(0) lgkmcnt(0)
    s_mov_b32 s67, 16777216
L_hold_23:
    ds_read_b32 v31, v251 offset:24
    s_sub_u32 s67, s67, 1
    s_cmp_eq_u32 s67, 0
    s_cbranch_scc1 L_holdd_24
    s_waitcnt lgkmcnt(0)
    v_cmp_gt_u32 vcc, 4, v31
    s_cbranch_vccnz L_hold_23
L_holdd_24:
    s_waitcnt lgkmcnt(0)
    s_add_u32 s64, s71, 9216
    buffer_load_dwordx4 v[100:103], v29, s[52:55], s64 offen offset:0
    buffer_load_dwordx4 v[108:111], v29, s[52:55], s64 offen offset:256
    buffer_load_dwordx4 v[116:119], v29, s[52:55], s64 offen offset:512
    buffer_load_dwordx4 v[124:127], v29, s[52:55], s64 offen offset:768
    s_add_u32 s64, s71, 2304
    buffer_load_dwordx4 v[128:131], v29, s[52:55], s64 offen offset:0
    buffer_load_dwordx4 v[136:139], v29, s[52:55], s64 offen offset:256
    buffer_load_dwordx4 v[144:147], v29, s[52:55], s64 offen offset:512
    buffer_load_dwordx4 v[152:155], v29, s[52:55], s64 offen offset:768
    s_add_u32 s64, s71, 11520
    buffer_load_dwordx4 v[132:135], v29, s[52:55], s64 offen offset:0
    buffer_load_dwordx4 v[140:143], v29, s[52:55], s64 offen offset:256
    buffer_load_dwordx4 v[148:151], v29, s[52:55], s64 offen offset:512
    buffer_load_dwordx4 v[156:159], v29, s[52:55], s64 offen offset:768
    s_barrier
    ds_read_b128 v[8:11], v4 offset:0
    ds_read_b128 v[12:15], v4 offset:64
    ds_read_b128 v[16:19], v4 offset:128
    ds_read_b128 v[20:23], v4 offset:192
    s_waitcnt lgkmcnt(3)
    v_mfma_f32_16x16x32_bf16 v[224:227], v[160:163], v[8:11], 0
    v_mfma_f32_16x16x32_bf16 v[228:231], v[192:195], v[8:11], 0
    ds_read_b128 v[8:11], v4 offset:256
    s_waitcnt lgkmcnt(3)
    v_mfma_f32_16x16x32_bf16 v[224:227], v[164:167], v[12:15], v[224:227]
    v_mfma_f32_16x16x32_bf16 v[228:231], v[196:199], v[12:15], v[228:231]
    ds_read_b128 v[12:15], v4 offset:320
    s_waitcnt lgkmcnt(3)
    v_mfma_f32_16x16x32_bf16 v[224:227], v[168:171], v[16:19], v[224:227]
    v_mfma_f32_16x16x32_bf16 v[228:231], v[200:203], v[16:19], v[228:231]
    ds_read_b128 v[16:19], v4 offset:384
    v_mov_b32 v160, 0
    v_mov_b32 v161, 0
    v_mov_b32 v162, 0
    v_mov_b32 v163, 0
    s_waitcnt lgkmcnt(3)
    v_mfma_f32_16x16x32_bf16 v[224:227], v[172:175], v[20:23], v[224:227]
    v_mfma_f32_16x16x32_bf16 v[228:231], v[204:207], v[20:23], v[228:231]
    ds_read_b128 v[20:23], v4 offset:448
    v_mov_b32 v164, 0
    v_mov_b32 v165, 0
    v_mov_b32 v166, 0
    v_mov_b32 v167, 0
    s_waitcnt lgkmcnt(3)
    v_mfma_f32_16x16x32_bf16 v[224:227], v[176:179], v[8:11], v[224:227]
    v_mfma_f32_16x16x32_bf16 v[228:231], v[208:211], v[8:11], v[228:231]
    v_mov_b32 v168, 0
    v_mov_b32 v169, 0
    v_mov_b32 v170, 0
    v_mov_b32 v171, 0
    s_waitcnt lgkmcnt(2)
    v_mfma_f32_16x16x32_bf16 v[224:227], v[180:183], v[12:15], v[224:227]
    v_mfma_f32_16x16x32_bf16 v[228:231], v[212:215], v[12:15], v[228:231]
    v_mov_b32 v172, 0
    v_mov_b32 v173, 0
    v_mov_b32 v174, 0
    v_mov_b32 v175, 0
    s_waitcnt lgkmcnt(1)
    v_mfma_f32_16x16x32_bf16 v[224:227], v[184:187], v[16:19], v[224:227]
    v_mfma_f32_16x16x32_bf16 v[228:231], v[216:219], v[16:19], v[228:231]
    v_mov_b32 v176, 0
    v_mov_b32 v177, 0
    v_mov_b32 v178, 0
    v_mov_b32 v179, 0
    s_waitcnt lgkmcnt(0)
    v_mfma_f32_16x16x32_bf16 v[224:227], v[188:191], v[20:23], v[224:227]
    v_mfma_f32_16x16x32_bf16 v[228:231], v[220:223], v[20:23], v[228:231]
    ds_read_b128 v[192:195], v6 offset:0
    ds_read_b128 v[196:199], v6 offset:1024
    ds_read_b128 v[200:203], v6 offset:256
    ds_read_b128 v[204:207], v6 offset:1280
    ds_read_b128 v[208:211], v7 offset:0
    ds_read_b128 v[212:215], v7 offset:1024
    ds_read_b128 v[216:219], v7 offset:256
    ds_read_b128 v[220:223], v7 offset:1280
    v_cvt_pk_bf16_f32 v24, v224, v225
    v_and_b32 v8, v24, v244
    v_and_b32 v9, v24, v245
    v_and_b32 v10, v24, v246
    v_and_b32 v11, v24, v247
    v_cvt_pk_bf16_f32 v25, v226, v227
    v_cvt_pk_bf16_f32 v26, v228, v229
    v_cvt_pk_bf16_f32 v27, v230, v231
    v_smfmac_f32_16x16x64_bf16 v[160:163], v[8:11], v[32:39], v248
    v_and_b32 v12, v25, v244
    v_and_b32 v13, v25, v245
    v_smfmac_f32_16x16x64_bf16 v[164:167], v[8:11], v[40:47], v248
    v_and_b32 v14, v25, v246
    v_and_b32 v15, v25, v247
    v_smfmac_f32_16x16x64_bf16 v[168:171], v[8:11], v[48:55], v248
    v_smfmac_f32_16x16x64_bf16 v[172:175], v[8:11], v[56:63], v248
    v_smfmac_f32_16x16x64_bf16 v[160:163], v[12:15], v[64:71], v248
    v_and_b32 v16, v26, v244
    v_and_b32 v17, v26, v245
    v_smfmac_f32_16x16x64_bf16 v[164:167], v[12:15], v[72:79], v248
    v_and_b32 v18, v26, v246
    v_and_b32 v19, v26, v247
    v_smfmac_f32_16x16x64_bf16 v[168:171], v[12:15], v[80:87], v248
    v_smfmac_f32_16x16x64_bf16 v[172:175], v[12:15], v[88:95], v248
    s_waitcnt vmcnt(8)
    v_smfmac_f32_16x16x64_bf16 v[160:163], v[16:19], v[96:103], v248
    v_and_b32 v20, v27, v244
    v_and_b32 v21, v27, v245
    v_smfmac_f32_16x16x64_bf16 v[164:167], v[16:19], v[104:111], v248
    v_and_b32 v22, v27, v246
    v_and_b32 v23, v27, v247
    v_smfmac_f32_16x16x64_bf16 v[168:171], v[16:19], v[112:119], v248
    v_smfmac_f32_16x16x64_bf16 v[172:175], v[16:19], v[120:127], v248
    s_waitcnt vmcnt(0)
    v_smfmac_f32_16x16x64_bf16 v[160:163], v[20:23], v[128:135], v248
    v_smfmac_f32_16x16x64_bf16 v[164:167], v[20:23], v[136:143], v248
    v_smfmac_f32_16x16x64_bf16 v[168:171], v[20:23], v[144:151], v248
    v_smfmac_f32_16x16x64_bf16 v[172:175], v[20:23], v[152:159], v248
    s_waitcnt lgkmcnt(0)
    v_smfmac_f32_16x16x64_bf16 v[176:179], v[8:11], v[192:199], v248
    v_smfmac_f32_16x16x64_bf16 v[176:179], v[12:15], v[200:207], v248
    v_smfmac_f32_16x16x64_bf16 v[176:179], v[16:19], v[208:215], v248
    v_smfmac_f32_16x16x64_bf16 v[176:179], v[20:23], v[216:223], v248
    ds_write_b128 v5, v[160:163] offset:0
    ds_write_b128 v5, v[164:167] offset:512
    ds_write_b128 v5, v[168:171] offset:1024
    ds_write_b128 v5, v[172:175] offset:1536
    s_mov_b32 exec_lo, 0x00ff00ff
    s_mov_b32 exec_hi, 0x00ff00ff
    s_nop 1
    ds_write_b128 v5, v[176:179] offset:2048
    s_mov_b64 exec, -1
    s_waitcnt lgkmcnt(0)
    s_branch L_H_join
L_H_gather:
    s_add_u32 s48, s16, s56
    s_addc_u32 s49, s17, 0
    s_sub_u32 s50, 4194304, s56
    s_mov_b32 s51, 0x20000
    s_sub_u32 s70, s35, 4
    s_lshl_b32 s64, s39, 8
    s_lshl_b32 s65, s70, 6
    s_add_u32 s64, s64, s65
    v_add_u32 v232, s64, v2
    v_lshlrev_b32 v232, 13, v232
    v_lshlrev_b32 v5, 2, v2
    v_xor_b32 v5, v5, v3
    v_lshl_add_u32 v232, v5, 4, v232
    v_xor_b32 v233, 16, v232
    v_xor_b32 v234, 32, v232
    v_xor_b32 v235, 48, v232
    s_lshl_b32 s78, s70, 14
    s_mov_b32 s79, 0
    s_mov_b32 s67, 16777216
L_hold_25:
    ds_read_b32 v31, v251 offset:16
    s_sub_u32 s67, s67, 1
    s_cmp_eq_u32 s67, 0
    s_cbranch_scc1 L_holdd_26
    s_sleep 2
    s_waitcnt lgkmcnt(0)
    v_cmp_gt_u32 vcc, 4, v31
    s_cbranch_vccnz L_hold_25
L_holdd_26:
    s_waitcnt lgkmcnt(0)
    s_waitcnt vmcnt(0)
    v_mov_b32 v31, 1
    s_mov_b64 exec, 1
    ds_add_u32 v251, v31 offset:40
    s_mov_b64 exec, -1
    s_mov_b32 s67, 16777216
L_hold_44:
    ds_read_b32 v31, v251 offset:12
    s_sub_u32 s67, s67, 1
    s_cmp_eq_u32 s67, 0
    s_cbranch_scc1 L_holdd_45
    s_sleep 2
    s_waitcnt lgkmcnt(0)
    v_cmp_gt_u32 vcc, 4, v31
    s_cbranch_vccnz L_hold_44
L_holdd_45:
    s_waitcnt lgkmcnt(0)
    s_branch L_uvf_27
L_uvf_27:
    s_mov_b32 m0, s78
    s_add_u32 s78, s78, 1024
    buffer_load_dwordx4 v232, s[48:51], s79 offen nt lds
    s_add_u32 s79, s79, 32768
L_uvf_28:
    s_mov_b32 m0, s78
    s_add_u32 s78, s78, 1024
    buffer_load_dwordx4 v233, s[48:51], s79 offen nt lds
    s_add_u32 s79, s79, 32768
L_uvf_29:
    s_mov_b32 m0, s78
    s_add_u32 s78, s78, 1024
    buffer_load_dwordx4 v234, s[48:51], s79 offen nt lds
    s_add_u32 s79, s79, 32768
L_uvf_30:
    s_mov_b32 m0, s78
    s_add_u32 s78, s78, 1024
    buffer_load_dwordx4 v235, s[48:51], s79 offen nt lds
    s_add_u32 s79, s79, 32768
L_uvf_31:
    s_mov_b32 m0, s78
    s_add_u32 s78, s78, 1024
    buffer_load_dwordx4 v232, s[48:51], s79 offen nt lds
    s_add_u32 s79, s79, 32768
L_uvf_32:
    s_mov_b32 m0, s78
    s_add_u32 s78, s78, 1024
    buffer_load_dwordx4 v233, s[48:51], s79 offen nt lds
    s_add_u32 s79, s79, 32768
L_uvf_33:
    s_mov_b32 m0, s78
    s_add_u32 s78, s78, 1024
    buffer_load_dwordx4 v234, s[48:51], s79 offen nt lds
    s_add_u32 s79, s79, 32768
L_uvf_34:
    s_mov_b32 m0, s78
    s_add_u32 s78, s78, 1024
    buffer_load_dwordx4 v235, s[48:51], s79 offen nt lds
    s_add_u32 s79, s79, 32768
L_uvf_35:
    s_mov_b32 m0, s78
    s_add_u32 s78, s78, 1024
    buffer_load_dwordx4 v232, s[48:51], s79 offen nt lds
    s_add_u32 s79, s79, 32768
L_uvf_36:
    s_mov_b32 m0, s78
    s_add_u32 s78, s78, 1024
    buffer_load_dwordx4 v233, s[48:51], s79 offen nt lds
    s_add_u32 s79, s79, 32768
L_uvf_37:
    s_mov_b32 m0, s78
    s_add_u32 s78, s78, 1024
    buffer_load_dwordx4 v234, s[48:51], s79 offen nt lds
    s_add_u32 s79, s79, 32768
L_uvf_38:
    s_mov_b32 m0, s78
    s_add_u32 s78, s78, 1024
    buffer_load_dwordx4 v235, s[48:51], s79 offen nt lds
    s_add_u32 s79, s79, 32768
L_uvf_39:
    s_mov_b32 m0, s78
    s_add_u32 s78, s78, 1024
    buffer_load_dwordx4 v232, s[48:51], s79 offen nt lds
    s_add_u32 s79, s79, 32768
L_uvf_40:
    s_mov_b32 m0, s78
    s_add_u32 s78, s78, 1024
    buffer_load_dwordx4 v233, s[48:51], s79 offen nt lds
    s_add_u32 s79, s79, 32768
L_uvf_41:
    s_mov_b32 m0, s78
    s_add_u32 s78, s78, 1024
    buffer_load_dwordx4 v234, s[48:51], s79 offen nt lds
    s_add_u32 s79, s79, 32768
L_uvf_42:
    s_mov_b32 m0, s78
    s_add_u32 s78, s78, 1024
    buffer_load_dwordx4 v235, s[48:51], s79 offen nt lds
    s_add_u32 s79, s79, 32768
L_uvf_43:
    s_sub_u32 s70, s35, 4
    v_lshrrev_b32 v4, 3, v1
    v_mul_u32_u24 v4, 1152, v4
    v_and_b32 v5, 7, v1
    v_lshl_add_u32 v4, v5, 4, v4
    s_lshl_b32 s73, s70, 12
    s_add_u32 s73, s73, 65536
    s_mul_i32 s74, s70, 36864
    s_add_u32 s74, s74, 1024
    s_mov_b32 m0, s73
    s_nop 0
    buffer_load_dwordx4 v4, s[52:55], s74 offen lds
    s_add_u32 s73, s73, 1024
    s_add_u32 s74, s74, 9216
    s_mov_b32 m0, s73
    s_nop 0
    buffer_load_dwordx4 v4, s[52:55], s74 offen lds
    s_add_u32 s73, s73, 1024
    s_add_u32 s74, s74, 9216
    s_mov_b32 m0, s73
    s_nop 0
    buffer_load_dwordx4 v4, s[52:55], s74 offen lds
    s_add_u32 s73, s73, 1024
    s_add_u32 s74, s74, 9216
    s_mov_b32 m0, s73
    s_nop 0
    buffer_load_dwordx4 v4, s[52:55], s74 offen lds
    s_lshr_b32 s64, s38, 4
    s_lshl_b32 s64, s64, 13
    s_add_u32 s64, s64, 16384
    v_lshl_add_u32 v8, v1, 7, s64
    s_cmp_lg_u32 s35, 7
    s_cbranch_scc1 L_ofl0_46
    s_mov_b32 s64, 4096
    buffer_load_dwordx4 v[12:15], v8, s[40:43], s64 offen sc1
L_ofl0_46:
    v_mov_b32 v31, 1
    s_mov_b64 exec, 1
    ds_add_u32 v251, v31 offset:32
    s_mov_b64 exec, -1
    s_lshr_b32 s64, s70, 1
    s_and_b32 s65, s70, 1
    v_and_b32 v4, 7, v3
    v_lshl_add_u32 v4, v2, 3, v4
    v_lshlrev_b32 v4, 8, v4
    s_lshl_b32 s66, s64, 13
    s_lshl_b32 s67, s38, 3
    s_add_u32 s66, s66, s67
    s_add_u32 s71, s66, 196608
    v_lshrrev_b32 v5, 1, v2
    v_lshlrev_b32 v5, 3, v5
    v_and_b32 v6, 1, v2
    v_add_u32 v5, v5, v6
    v_mul_u32_u24 v5, 33280, v5
    v_lshl_add_u32 v5, v3, 4, v5
    s_mul_i32 s66, s64, 1064960
    s_add_u32 s66, s66, s58
    s_lshl_b32 s67, s65, 8
    s_add_u32 s66, s66, s67
    s_add_u32 s72, s66, 1048576
    s_add_u32 s73, s72, 532480
    s_add_u32 s74, s72, 66560
    s_add_u32 s75, s72, 599040
    s_add_u32 s76, s72, 133120
    s_add_u32 s77, s72, 665600
    s_add_u32 s78, s72, 199680
    s_add_u32 s79, s72, 732160
    s_mul_i32 s64, s64, 576
    s_add_u32 s64, s64, s67
    s_add_u32 s64, s64, 102400
    v_lshlrev_b32 v7, 3, v6
    v_lshl_add_u32 v7, v3, 4, v7
    v_add_u32 v7, s64, v7
    v_mov_b32 v24, 0
    v_mov_b32 v25, 0
    v_mov_b32 v26, 0
    v_mov_b32 v27, 0
    s_waitcnt vmcnt(0)
    v_mov_b32 v31, 1
    s_mov_b64 exec, 1
    ds_add_u32 v251, v31 offset:28
    s_mov_b64 exec, -1
    s_cmp_lg_u32 s35, 7
    s_cbranch_scc1 L_ofl_47
    s_mov_b32 s66, 2097152
    s_mov_b32 s64, 4096
    s_branch L_flm_50
L_fl_48:
    buffer_load_dwordx4 v[12:15], v8, s[40:43], s64 offen sc1
L_flm_50:
    s_waitcnt vmcnt(0)
    v_xor_b32 v12, s60, v12
    v_xor_b32 v13, s61, v13
    v_xor_b32 v14, s62, v14
    v_xor_b32 v15, s63, v15
    v_or3_b32 v12, v12, v13, v14
    v_or_b32 v12, v12, v15
    v_cmp_ne_u32 vcc, 0, v12
    s_cbranch_vccz L_fld_49
    s_sleep 8
    s_sub_u32 s66, s66, 1
    s_cmp_lg_u32 s66, 0
    s_cbranch_scc1 L_fl_48
L_fld_49:
    v_mov_b32 v31, 1
    s_mov_b64 exec, 1
    ds_add_u32 v251, v31 offset:20
    s_mov_b64 exec, -1
L_ofl_47:
    s_mov_b32 s67, 16777216
L_hold_51:
    ds_read_b32 v31, v251 offset:20
    s_sub_u32 s67, s67, 1
    s_cmp_eq_u32 s67, 0
    s_cbranch_scc1 L_holdd_52
    s_sleep 2
    s_waitcnt lgkmcnt(0)
    v_cmp_gt_u32 vcc, 1, v31
    s_cbranch_vccnz L_hold_51
L_holdd_52:
    s_waitcnt lgkmcnt(0)
    s_mov_b32 s67, 16777216
L_hold_53:
    ds_read_b32 v31, v251 offset:36
    s_sub_u32 s67, s67, 1
    s_cmp_eq_u32 s67, 0
    s_cbranch_scc1 L_holdd_54
    s_sleep 2
    s_waitcnt lgkmcnt(0)
    v_cmp_gt_u32 vcc, 4, v31
    s_cbranch_vccnz L_hold_53
L_holdd_54:
    s_waitcnt lgkmcnt(0)
    s_mov_b32 s66, 2097152
L_bm_55:
    buffer_load_dwordx2 v[8:9], v4, s[40:43], s71 offen sc1
    s_sub_u32 s66, s66, 1
    s_cmp_eq_u32 s66, 0
    s_waitcnt vmcnt(0)
    s_cbranch_scc1 L_bmd_56
    v_max_u32 v10, v8, v9
    v_cmp_eq_u32 vcc, -1, v10
    s_cbranch_vccz L_bmd_56
    s_sleep 2
    s_branch L_bm_55
L_bmd_56:
    v_max_f32_dpp v10, v8, v8 quad_perm:[1,0,3,2] row_mask:0xf bank_mask:0xf
    s_nop 1
    v_max_f32_dpp v10, v10, v10 quad_perm:[2,3,0,1] row_mask:0xf bank_mask:0xf
    s_nop 1
    v_max_f32_dpp v10, v10, v10 row_half_mirror row_mask:0xf bank_mask:0xf
    v_mov_b32 v11, v10
    s_nop 1
    v_permlane16_swap_b32 v10, v11
    v_max_f32 v10, v10, v11
    v_mov_b32 v11, v10
    s_nop 1
    v_permlane32_swap_b32 v10, v11
    v_max_f32 v10, v10, v11
    v_sub_f32 v8, v8, v10
    v_exp_f32 v8, v8
    s_nop 1
    v_mov_b32_dpp v10, v8 quad_perm:[1,1,3,3] row_mask:0xf bank_mask:0xf
    v_cvt_pk_bf16_f32 v11, v8, v8
    v_cvt_pk_bf16_f32 v12, v8, v10
    v_lshlrev_b32 v11, 16, v11
    v_mul_f32 v9, v9, v11
    s_nop 1
    v_add_f32_dpp v9, v9, v9 quad_perm:[1,0,3,2] row_mask:0xf bank_mask:0xf
    s_nop 1
    v_add_f32_dpp v9, v9, v9 quad_perm:[2,3,0,1] row_mask:0xf bank_mask:0xf
    s_nop 1
    v_add_f32_dpp v9, v9, v9 row_half_mirror row_mask:0xf bank_mask:0xf
    v_mov_b32 v11, v9
    s_nop 1
    v_permlane16_swap_b32 v9, v11
    v_add_f32 v9, v9, v11
    v_mov_b32 v11, v9
    s_nop 1
    v_permlane32_swap_b32 v9, v11
    v_add_f32 v9, v9, v11
    v_rcp_f32 v9, v9
    v_and_b32_dpp v64, v12, v244 row_newbcast:0 row_mask:0xf bank_mask:0xf
    v_and_b32_dpp v65, v12, v245 row_newbcast:0 row_mask:0xf bank_mask:0xf
    v_and_b32_dpp v66, v12, v246 row_newbcast:0 row_mask:0xf bank_mask:0xf
    v_and_b32_dpp v67, v12, v247 row_newbcast:0 row_mask:0xf bank_mask:0xf
    v_and_b32_dpp v68, v12, v244 row_newbcast:2 row_mask:0xf bank_mask:0xf
    v_and_b32_dpp v69, v12, v245 row_newbcast:2 row_mask:0xf bank_mask:0xf
    v_and_b32_dpp v70, v12, v246 row_newbcast:2 row_mask:0xf bank_mask:0xf
    v_and_b32_dpp v71, v12, v247 row_newbcast:2 row_mask:0xf bank_mask:0xf
    v_and_b32_dpp v72, v12, v244 row_newbcast:4 row_mask:0xf bank_mask:0xf
    v_and_b32_dpp v73, v12, v245 row_newbcast:4 row_mask:0xf bank_mask:0xf
    v_and_b32_dpp v74, v12, v246 row_newbcast:4 row_mask:0xf bank_mask:0xf
    v_and_b32_dpp v75, v12, v247 row_newbcast:4 row_mask:0xf bank_mask:0xf
    v_and_b32_dpp v76, v12, v244 row_newbcast:6 row_mask:0xf bank_mask:0xf
    v_and_b32_dpp v77, v12, v245 row_newbcast:6 row_mask:0xf bank_mask:0xf
    v_and_b32_dpp v78, v12, v246 row_newbcast:6 row_mask:0xf bank_mask:0xf
    v_and_b32_dpp v79, v12, v247 row_newbcast:6 row_mask:0xf bank_mask:0xf
    buffer_load_dwordx4 v[32:35], v5, s[40:43], s72 offen sc1
    buffer_load_dwordx4 v[36:39], v5, s[40:43], s73 offen sc1
    buffer_load_dwordx4 v[40:43], v5, s[40:43], s74 offen sc1
    buffer_load_dwordx4 v[44:47], v5, s[40:43], s75 offen sc1
    buffer_load_dwordx4 v[48:51], v5, s[40:43], s76 offen sc1
    buffer_load_dwordx4 v[52:55], v5, s[40:43], s77 offen sc1
    buffer_load_dwordx4 v[56:59], v5, s[40:43], s78 offen sc1
    buffer_load_dwordx4 v[60:63], v5, s[40:43], s79 offen sc1
    v_mov_b32 v31, 1
    s_mov_b64 exec, 1
    ds_add_u32 v251, v31 offset:24
    s_mov_b64 exec, -1
    s_mov_b32 s66, 2097152
    s_waitcnt vmcnt(0)
    s_branch L_pdm_59
L_pd_57:
    buffer_load_dwordx4 v[32:35], v5, s[40:43], s72 offen sc1
    buffer_load_dwordx4 v[36:39], v5, s[40:43], s73 offen sc1
    buffer_load_dwordx4 v[40:43], v5, s[40:43], s74 offen sc1
    buffer_load_dwordx4 v[44:47], v5, s[40:43], s75 offen sc1
    buffer_load_dwordx4 v[48:51], v5, s[40:43], s76 offen sc1
    buffer_load_dwordx4 v[52:55], v5, s[40:43], s77 offen sc1
    buffer_load_dwordx4 v[56:59], v5, s[40:43], s78 offen sc1
    buffer_load_dwordx4 v[60:63], v5, s[40:43], s79 offen sc1
    s_sub_u32 s66, s66, 1
    s_cmp_eq_u32 s66, 0
    s_waitcnt vmcnt(0)
    s_cbranch_scc1 L_pdd_58
L_pdm_59:
    v_max3_u32 v10, v32, v33, v34
    v_max3_u32 v10, v10, v35, v36
    v_max3_u32 v10, v10, v37, v38
    v_max3_u32 v10, v10, v39, v40
    v_max3_u32 v10, v10, v41, v42
    v_max3_u32 v10, v10, v43, v44
    v_max3_u32 v10, v10, v45, v46
    v_max3_u32 v10, v10, v47, v48
    v_max3_u32 v10, v10, v49, v50
    v_max3_u32 v10, v10, v51, v52
    v_max3_u32 v10, v10, v53, v54
    v_max3_u32 v10, v10, v55, v56
    v_max3_u32 v10, v10, v57, v58
    v_max3_u32 v10, v10, v59, v60
    v_max3_u32 v10, v10, v61, v62
    v_max_u32 v10, v10, v63
    v_cmp_eq_u32 vcc, -1, v10
    s_cbranch_vccnz L_pd_57
L_pdd_58:
    v_smfmac_f32_16x16x64_bf16 v[24:27], v[64:67], v[32:39], v248
    v_smfmac_f32_16x16x64_bf16 v[24:27], v[68:71], v[40:47], v248
    v_smfmac_f32_16x16x64_bf16 v[24:27], v[72:75], v[48:55], v248
    v_smfmac_f32_16x16x64_bf16 v[24:27], v[76:79], v[56:63], v248
    s_nop 7
    v_mul_f32 v24, v24, v9
    v_mul_f32 v25, v25, v9
    v_mul_f32 v26, v26, v9
    v_mul_f32 v27, v27, v9
    v_cvt_pk_bf16_f32 v10, v24, v25
    v_cvt_pk_bf16_f32 v11, v26, v27
    ds_write_b64 v7, v[10:11]
    s_waitcnt lgkmcnt(0)
    s_barrier
L_H_join:
    s_and_b32 s74, s60, 0xfff
    s_xor_b32 s75, s74, 0xfff
    s_mov_b32 s76, 0xfff
    v_mov_b32 v18, s74
    v_mov_b32 v19, s75
    s_barrier
    s_cmp_gt_u32 s35, 4
    s_cbranch_scc1 L_fr_60
    s_cmp_eq_u32 s35, 4
    s_cselect_b32 exec_hi, 0, -1
    ds_read_b128 v[32:35], v237 offset:0
    ds_read_b128 v[36:39], v237 offset:4608
    ds_read_b128 v[40:43], v237 offset:9216
    ds_read_b128 v[44:47], v237 offset:13824
    s_waitcnt lgkmcnt(2)
    v_pk_add_f32 v[32:33], v[32:33], v[36:37]
    v_pk_add_f32 v[34:35], v[34:35], v[38:39]
    s_waitcnt lgkmcnt(1)
    v_pk_add_f32 v[32:33], v[32:33], v[40:41]
    v_pk_add_f32 v[34:35], v[34:35], v[42:43]
    s_waitcnt lgkmcnt(0)
    v_pk_add_f32 v[32:33], v[32:33], v[44:45]
    v_pk_add_f32 v[34:35], v[34:35], v[46:47]
    v_add_u32 v32, 0x800, v32
    v_bfi_b32 v32, s76, v18, v32
    v_add_u32 v33, 0x800, v33
    v_bfi_b32 v33, s76, v18, v33
    v_add_u32 v34, 0x800, v34
    v_bfi_b32 v34, s76, v19, v34
    v_add_u32 v35, 0x800, v35
    v_bfi_b32 v35, s76, v19, v35
    buffer_store_dwordx4 v[32:35], v236, s[40:43], s57 offen sc1
    s_mov_b64 exec, -1
L_fr_60:
    s_endpgm
L_roleA:
    s_waitcnt lgkmcnt(0)
    s_load_dword s34, s[32:33], 0
    s_mov_b32 s40, s32
    s_mov_b32 s41, s33
    s_mov_b32 s42, 268435456
    s_mov_b32 s43, 0x20000
    v_mov_b32 v252, -1
    v_mov_b32 v253, -1
    v_mov_b32 v254, -1
    v_mov_b32 v255, -1
    v_lshlrev_b32 v4, 2, v1
    v_add_u32 v4, 160512, v4
    v_mov_b32 v5, 0xff800000
    v_cmp_gt_u32 vcc, 16, v1
    s_nop 1
    v_cndmask_b32 v5, 0, v5, vcc
    ds_write_b32 v4, v5
    s_sub_u32 s64, s35, 3
    s_cmp_gt_u32 s64, 1
    s_cbranch_scc1 L_pfuk_61
    s_sub_u32 s65, s37, 8
    s_lshr_b32 s66, s65, 3
    s_lshl_b32 s66, s66, 4
    s_and_b32 s65, s65, 7
    s_lshl_b32 s65, s65, 6
    s_add_u32 s65, s65, s66
    s_add_u32 s65, s65, 16
    s_lshl_b32 s64, s64, 3
    s_add_u32 s65, s65, s64
    v_lshrrev_b32 v5, 3, v1
    v_add_u32 v5, s65, v5
    v_and_b32 v6, 7, v1
    s_lshl_b32 s64, s36, 10
    v_lshl_add_u32 v6, v6, 7, s64
    v_lshl_add_u32 v5, v5, 13, v6
    global_load_dword v194, v5, s[14:15]
L_pfuk_61:
    s_cmp_lt_u32 s35, 4
    s_cbranch_scc1 L_aclr_62
    s_sub_u32 s64, s37, 8
    s_and_b32 s39, s64, 1
    s_lshr_b32 s64, s64, 1
    s_lshl_b32 s38, s36, 3
    s_add_u32 s38, s38, s64
    s_mul_i32 s57, s38, 33280
    s_lshl_b32 s64, s39, 14
    s_add_u32 s57, s57, s64
    s_add_u32 s57, s57, 1048576
    s_lshl_b32 s58, s38, 8
    s_lshl_b32 s64, s39, 7
    s_add_u32 s58, s58, s64
    s_add_u32 s58, s58, 196608
    s_sub_u32 s64, s35, 4
    s_lshl_b32 s64, s64, 12
    s_add_u32 s64, s64, s57
    v_lshlrev_b32 v4, 4, v1
    buffer_store_dwordx4 v[252:255], v4, s[40:43], s64 offen offset:0 sc1 nt
    buffer_store_dwordx4 v[252:255], v4, s[40:43], s64 offen offset:1024 sc1 nt
    buffer_store_dwordx4 v[252:255], v4, s[40:43], s64 offen offset:2048 sc1 nt
    buffer_store_dwordx4 v[252:255], v4, s[40:43], s64 offen offset:3072 sc1 nt
    v_and_b32 v4, 0x70, v4
    buffer_store_dwordx4 v[252:255], v4, s[40:43], s58 offen sc1
L_aclr_62:
    s_waitcnt lgkmcnt(0)
    s_add_u32 s60, s34, 0x9E3779B9
    s_mul_i32 s61, s60, 0x85EBCA6B
    s_not_b32 s62, s60
    s_xor_b32 s63, s60, 0x5A5AA5A5
L_A_go:
    s_sub_u32 s64, s37, 8
    s_and_b32 s39, s64, 1
    s_lshr_b32 s64, s64, 1
    s_lshl_b32 s38, s36, 3
    s_add_u32 s38, s38, s64
    s_mul_i32 s57, s38, 33280
    s_lshl_b32 s64, s39, 14
    s_add_u32 s57, s57, s64
    s_add_u32 s57, s57, 1048576
    s_lshl_b32 s58, s38, 8
    s_lshl_b32 s64, s39, 7
    s_add_u32 s58, s58, s64
    s_add_u32 s58, s58, 196608
    s_lshl_b32 s73, s35, 14
    s_lshl_b32 s64, s39, 13
    s_or_b32 s73, s73, s64
    s_lshl_b32 s64, s39, 5
    v_lshlrev_b32 v20, 4, v1
    v_xor_b32 v20, s64, v20
    s_lshl_b32 s56, s38, 17
    s_add_u32 s52, s10, s56
    s_addc_u32 s53, s11, 0
    s_sub_u32 s54, 8388608, s56
    s_mov_b32 s55, 0x20000
    v_mov_b32 v252, -1
    v_mov_b32 v253, -1
    v_mov_b32 v254, -1
    v_mov_b32 v255, -1
    s_lshl_b32 s64, s39, 12
    v_and_b32 v29, 31, v1
    v_lshl_add_u32 v29, v29, 7, s64
    s_mov_b32 s77, 4096
    v_and_b32 v5, 3, v3
    v_lshlrev_b32 v5, 2, v5
    v_lshrrev_b32 v6, 2, v3
    v_or_b32 v5, v5, v6
    s_lshl_b32 s64, s35, 4
    v_add_u32 v6, s64, v3
    v_lshlrev_b32 v6, 10, v6
    v_lshl_add_u32 v6, v2, 8, v6
    v_lshl_add_u32 v6, v5, 4, v6
    v_lshrrev_b32 v8, 2, v3
    v_lshl_add_u32 v9, v2, 3, v8
    v_lshlrev_b32 v9, 10, v9
    v_and_b32 v10, 1, v2
    v_lshlrev_b32 v10, 1, v10
    v_lshl_or_b32 v10, v8, 2, v10
    v_bfe_u32 v11, v3, 1, 1
    s_lshl_b32 s64, s35, 3
    v_add_u32 v11, s64, v11
    v_xor_b32 v10, v10, v11
    v_lshl_add_u32 v9, v10, 4, v9
    v_and_b32 v10, 1, v3
    v_lshl_add_u32 v9, v10, 3, v9
    v_xor_b32 v10, 16, v9
    v_add_u32 v10, 4096, v10
    s_mov_b32 s59, 0
    s_mov_b32 s64, 0
    v_mov_b32 v26, v6
    v_xor_b32 v24, s64, v9
    v_xor_b32 v25, s64, v10
    v_xor_b32 v236, 0, v24
    v_add_u32 v244, 65536, v236
    v_xor_b32 v237, 0, v25
    v_add_u32 v245, 65536, v237
    v_xor_b32 v238, 32, v24
    v_add_u32 v246, 65536, v238
    v_xor_b32 v239, 32, v25
    v_add_u32 v247, 65536, v239
    v_xor_b32 v240, 64, v24
    v_add_u32 v248, 65536, v240
    v_xor_b32 v241, 64, v25
    v_add_u32 v249, 65536, v241
    v_xor_b32 v242, 96, v24
    v_add_u32 v250, 65536, v242
    v_xor_b32 v243, 96, v25
    v_add_u32 v30, 65536, v243
    s_lshr_b32 s64, s38, 5
    s_lshl_b32 s64, s64, 15
    s_lshl_b32 s65, s39, 14
    s_add_u32 s64, s64, s65
    s_add_u32 s78, s64, 131072
    s_add_u32 s79, s78, 8192
    v_lshlrev_b32 v4, 4, v0
    s_mul_i32 s64, s35, 1040
    s_add_u32 s64, s64, 131072
    v_lshl_add_u32 v5, v1, 4, s64
    v_mul_u32_u24 v6, 1040, v3
    v_lshl_add_u32 v6, v2, 8, v6
    v_add_u32 v6, 131072, v6
    v_lshlrev_b32 v7, 2, v3
    v_add_u32 v7, 160512, v7
    v_mul_u32_u24 v16, 288, v3
    v_add_u32 v16, 147712, v16
    s_lshl_b32 s64, s35, 5
    v_lshl_add_u32 v17, v2, 3, s64
    v_add_u32 v17, v17, v16
    v_lshl_add_u32 v16, v2, 4, v16
    s_xor_b32 s64, s59, 0
    v_add_u32 v232, s64, v16
    s_xor_b32 s64, s59, 64
    v_add_u32 v233, s64, v16
    s_xor_b32 s64, s59, 128
    v_add_u32 v234, s64, v16
    s_xor_b32 s64, s59, 192
    v_add_u32 v235, s64, v16
    v_and_b32 v18, 7, v3
    v_lshlrev_b32 v18, 10, v18
    v_lshrrev_b32 v19, 3, v3
    v_lshl_add_u32 v18, v19, 6, v18
    v_and_b32 v19, 1, v2
    v_lshl_add_u32 v18, v19, 5, v18
    v_lshrrev_b32 v19, 1, v2
    v_lshl_add_u32 v18, v19, 4, v18
    s_lshl_b32 s64, s35, 7
    v_add_u32 v18, s64, v18
    v_lshlrev_b32 v19, 3, v1
    s_mov_b32 s72, 0x3e0293ee
    s_mov_b32 s4, s18
    s_mov_b32 s5, s19
    s_lshl_b32 s64, s38, 1
    s_add_u32 s64, s64, s39
    s_mul_i32 s64, s64, 36864
    v_min_u32 v22, 287, v0
    v_lshlrev_b32 v22, 7, v22
    v_add_u32 v22, s64, v22
    v_mov_b32 v251, 160256
    s_mov_b32 s67, 16777216
L_hold_63:
    ds_read_b32 v31, v251 offset:0
    s_sub_u32 s67, s67, 1
    s_cmp_eq_u32 s67, 0
    s_cbranch_scc1 L_holdd_64
    s_sleep 2
    s_waitcnt lgkmcnt(0)
    v_cmp_gt_u32 vcc, 2, v31
    s_cbranch_vccnz L_hold_63
L_holdd_64:
    s_waitcnt lgkmcnt(0)
    s_cmp_lt_u32 s35, 4
    s_cbranch_scc1 L_afl_65
    s_waitcnt vmcnt(0)
    v_mov_b32 v31, 1
    s_mov_b64 exec, 1
    ds_add_u32 v251, v31 offset:48
    s_mov_b64 exec, -1
    s_cmp_lg_u32 s35, 7
    s_cbranch_scc1 L_afl_65
    s_mov_b32 s67, 16777216
L_hold_66:
    ds_read_b32 v31, v251 offset:48
    s_sub_u32 s67, s67, 1
    s_cmp_eq_u32 s67, 0
    s_cbranch_scc1 L_holdd_67
    s_sleep 2
    s_waitcnt lgkmcnt(0)
    v_cmp_gt_u32 vcc, 4, v31
    s_cbranch_vccnz L_hold_66
L_holdd_67:
    s_waitcnt lgkmcnt(0)
    s_lshl_b32 s65, s39, 6
    s_add_u32 s65, s65, s38
    v_mov_b32 v252, s60
    v_mov_b32 v253, s61
    v_mov_b32 v254, s62
    v_mov_b32 v255, s63
    s_lshl_b32 s64, s65, 7
    s_add_u32 s64, s64, 20480
    s_mov_b64 exec, 1
    buffer_store_dwordx4 v[252:255], v1, s[40:43], s64 offen sc1
    s_mov_b64 exec, -1
L_afl_65:
    s_xor_b32 s74, s73, 0
    s_mov_b32 m0, s74
    v_xor_b32 v21, 0, v20
    buffer_load_dwordx4 v21, s[52:55], s74 offen  lds
    s_xor_b32 s74, s73, 1024
    s_mov_b32 m0, s74
    v_xor_b32 v21, 64, v20
    buffer_load_dwordx4 v21, s[52:55], s74 offen  lds
    s_xor_b32 s74, s73, 2048
    s_mov_b32 m0, s74
    v_xor_b32 v21, 128, v20
    buffer_load_dwordx4 v21, s[52:55], s74 offen  lds
    s_xor_b32 s74, s73, 3072
    s_mov_b32 m0, s74
    v_xor_b32 v21, 192, v20
    buffer_load_dwordx4 v21, s[52:55], s74 offen  lds
    s_xor_b32 s74, s73, 4096
    s_mov_b32 m0, s74
    v_xor_b32 v21, 16, v20
    buffer_load_dwordx4 v21, s[52:55], s74 offen  lds
    s_xor_b32 s74, s73, 5120
    s_mov_b32 m0, s74
    v_xor_b32 v21, 80, v20
    buffer_load_dwordx4 v21, s[52:55], s74 offen  lds
    s_xor_b32 s74, s73, 6144
    s_mov_b32 m0, s74
    v_xor_b32 v21, 144, v20
    buffer_load_dwordx4 v21, s[52:55], s74 offen  lds
    s_xor_b32 s74, s73, 7168
    s_mov_b32 m0, s74
    v_xor_b32 v21, 208, v20
    buffer_load_dwordx4 v21, s[52:55], s74 offen  lds
    s_cmp_lg_u32 s35, 0
    s_cbranch_scc1 L_afl0_68
    buffer_load_dwordx4 v[228:231], v29, s[40:43], s77 offen sc1
L_afl0_68:
    s_xor_b32 s74, s73, 8192
    s_mov_b32 m0, s74
    v_xor_b32 v21, 32, v20
    buffer_load_dwordx4 v21, s[52:55], s74 offen  lds
    s_xor_b32 s74, s73, 9216
    s_mov_b32 m0, s74
    v_xor_b32 v21, 96, v20
    buffer_load_dwordx4 v21, s[52:55], s74 offen  lds
    s_xor_b32 s74, s73, 10240
    s_mov_b32 m0, s74
    v_xor_b32 v21, 160, v20
    buffer_load_dwordx4 v21, s[52:55], s74 offen  lds
    s_xor_b32 s74, s73, 11264
    s_mov_b32 m0, s74
    v_xor_b32 v21, 224, v20
    buffer_load_dwordx4 v21, s[52:55], s74 offen  lds
    s_cmp_lg_u32 s35, 0
    s_cbranch_scc1 L_akw_70
    s_waitcnt vmcnt(4)
    v_xor_b32 v228, s60, v228
    v_xor_b32 v229, s61, v229
    v_xor_b32 v230, s62, v230
    v_xor_b32 v231, s63, v231
    v_or3_b32 v228, v228, v229, v230
    v_or_b32 v228, v228, v231
    v_cmp_ne_u32 vcc, 0, v228
    s_cbranch_vccz L_akw_69
    s_mov_b32 s66, 2097152
    s_mov_b32 s64, 4096
L_fl_71:
    buffer_load_dwordx4 v[228:231], v29, s[40:43], s64 offen sc1
    s_waitcnt vmcnt(0)
    v_xor_b32 v228, s60, v228
    v_xor_b32 v229, s61, v229
    v_xor_b32 v230, s62, v230
    v_xor_b32 v231, s63, v231
    v_or3_b32 v228, v228, v229, v230
    v_or_b32 v228, v228, v231
    v_cmp_ne_u32 vcc, 0, v228
    s_cbranch_vccz L_fld_72
    s_sleep 8
    s_sub_u32 s66, s66, 1
    s_cmp_lg_u32 s66, 0
    s_cbranch_scc1 L_fl_71
L_fld_72:
L_akw_69:
    v_mov_b32 v31, 1
    s_mov_b64 exec, 1
    ds_add_u32 v251, v31 offset:4
    s_mov_b64 exec, -1
L_akw_70:
    s_mov_b32 s67, 16777216
L_hold_73:
    ds_read_b32 v31, v251 offset:4
    s_sub_u32 s67, s67, 1
    s_cmp_eq_u32 s67, 0
    s_cbranch_scc1 L_holdd_74
    s_sleep 2
    s_waitcnt lgkmcnt(0)
    v_cmp_gt_u32 vcc, 1, v31
    s_cbranch_vccnz L_hold_73
L_holdd_74:
    s_waitcnt lgkmcnt(0)
    buffer_load_dwordx4 v[8:11], v4, s[40:43], s78 offen sc1
    buffer_load_dwordx4 v[12:15], v4, s[40:43], s79 offen sc1
    s_xor_b32 s74, s73, 12288
    s_mov_b32 m0, s74
    v_xor_b32 v21, 48, v20
    buffer_load_dwordx4 v21, s[52:55], s74 offen  lds
    s_xor_b32 s74, s73, 13312
    s_mov_b32 m0, s74
    v_xor_b32 v21, 112, v20
    buffer_load_dwordx4 v21, s[52:55], s74 offen  lds
    s_xor_b32 s74, s73, 14336
    s_mov_b32 m0, s74
    v_xor_b32 v21, 176, v20
    buffer_load_dwordx4 v21, s[52:55], s74 offen  lds
    s_xor_b32 s74, s73, 15360
    s_mov_b32 m0, s74
    v_xor_b32 v21, 240, v20
    buffer_load_dwordx4 v21, s[52:55], s74 offen  lds
    s_waitcnt vmcnt(4)
    v_max3_u32 v20, v8, v9, v10
    v_max3_u32 v21, v11, v12, v13
    v_max3_u32 v20, v20, v14, v15
    v_max_u32 v20, v20, v21
    v_cmp_eq_u32 vcc, -1, v20
    s_cbranch_vccnz L_qal_75
    ds_write_b128 v5, v[8:11]
    ds_write_b128 v5, v[12:15] offset:8320
    s_waitcnt vmcnt(0)
    v_xor_b32 v27, 0, v26
    ds_read_b128 v[32:35], v27
    v_xor_b32 v27, 16, v26
    ds_read_b128 v[36:39], v27
    v_xor_b32 v27, 32, v26
    ds_read_b128 v[40:43], v27
    v_xor_b32 v27, 48, v26
    ds_read_b128 v[44:47], v27
    v_xor_b32 v27, 64, v26
    ds_read_b128 v[48:51], v27
    v_xor_b32 v27, 80, v26
    ds_read_b128 v[52:55], v27
    v_xor_b32 v27, 96, v26
    ds_read_b128 v[56:59], v27
    v_xor_b32 v27, 112, v26
    ds_read_b128 v[60:63], v27
    v_xor_b32 v27, 128, v26
    ds_read_b128 v[64:67], v27
    v_xor_b32 v27, 144, v26
    ds_read_b128 v[68:71], v27
    v_xor_b32 v27, 160, v26
    ds_read_b128 v[72:75], v27
    v_xor_b32 v27, 176, v26
    ds_read_b128 v[76:79], v27
    v_xor_b32 v27, 192, v26
    ds_read_b128 v[80:83], v27
    v_xor_b32 v27, 208, v26
    ds_read_b128 v[84:87], v27
    v_xor_b32 v27, 224, v26
    ds_read_b128 v[88:91], v27
    v_xor_b32 v27, 240, v26
    ds_read_b128 v[92:95], v27
    s_branch L_qaj_78
L_qal_75:
    buffer_load_dwordx4 v[8:11], v4, s[40:43], s78 offen sc1
    buffer_load_dwordx4 v[12:15], v4, s[40:43], s79 offen sc1
    s_mov_b32 s66, 2097152
    s_waitcnt vmcnt(2)
    v_xor_b32 v27, 0, v26
    ds_read_b128 v[32:35], v27
    v_xor_b32 v27, 16, v26
    ds_read_b128 v[36:39], v27
    v_xor_b32 v27, 32, v26
    ds_read_b128 v[40:43], v27
    v_xor_b32 v27, 48, v26
    ds_read_b128 v[44:47], v27
    v_xor_b32 v27, 64, v26
    ds_read_b128 v[48:51], v27
    v_xor_b32 v27, 80, v26
    ds_read_b128 v[52:55], v27
    v_xor_b32 v27, 96, v26
    ds_read_b128 v[56:59], v27
    v_xor_b32 v27, 112, v26
    ds_read_b128 v[60:63], v27
    v_xor_b32 v27, 128, v26
    ds_read_b128 v[64:67], v27
    v_xor_b32 v27, 144, v26
    ds_read_b128 v[68:71], v27
    v_xor_b32 v27, 160, v26
    ds_read_b128 v[72:75], v27
    v_xor_b32 v27, 176, v26
    ds_read_b128 v[76:79], v27
    v_xor_b32 v27, 192, v26
    ds_read_b128 v[80:83], v27
    v_xor_b32 v27, 208, v26
    ds_read_b128 v[84:87], v27
    v_xor_b32 v27, 224, v26
    ds_read_b128 v[88:91], v27
    v_xor_b32 v27, 240, v26
    ds_read_b128 v[92:95], v27
L_qap_76:
    s_waitcnt vmcnt(0)
    v_max3_u32 v20, v8, v9, v10
    v_max3_u32 v21, v11, v12, v13
    v_max3_u32 v20, v20, v14, v15
    v_max_u32 v20, v20, v21
    v_cmp_eq_u32 vcc, -1, v20
    s_cbranch_vccz L_qad_77
    s_sub_u32 s66, s66, 1
    s_cmp_eq_u32 s66, 0
    s_cbranch_scc1 L_qad_77
    buffer_load_dwordx4 v[8:11], v4, s[40:43], s78 offen sc1
    buffer_load_dwordx4 v[12:15], v4, s[40:43], s79 offen sc1
    s_branch L_qap_76
L_qad_77:
    ds_write_b128 v5, v[8:11]
    ds_write_b128 v5, v[12:15] offset:8320
    s_waitcnt lgkmcnt(0)
L_qaj_78:
    s_waitcnt lgkmcnt(15)
    s_barrier
    global_load_dword v228, v22, s[4:5]
    ds_read_b128 v[160:163], v6 offset:0
    ds_read_b128 v[164:167], v6 offset:16
    ds_read_b128 v[168:171], v6 offset:32
    ds_read_b128 v[172:175], v6 offset:48
    ds_read_b128 v[176:179], v6 offset:64
    ds_read_b128 v[180:183], v6 offset:80
    ds_read_b128 v[184:187], v6 offset:96
    s_waitcnt lgkmcnt(6)
    v_mfma_f32_16x16x32_bf16 v[224:227], v[32:35], v[160:163], 0
    ds_read_b128 v[188:191], v6 offset:112
    s_waitcnt lgkmcnt(6)
    v_mfma_f32_16x16x32_bf16 v[224:227], v[36:39], v[164:167], v[224:227]
    ds_read_b128 v[192:195], v6 offset:128
    s_waitcnt lgkmcnt(6)
    v_mfma_f32_16x16x32_bf16 v[224:227], v[40:43], v[168:171], v[224:227]
    ds_read_b128 v[196:199], v6 offset:144
    s_waitcnt lgkmcnt(6)
    v_mfma_f32_16x16x32_bf16 v[224:227], v[44:47], v[172:175], v[224:227]
    ds_read_b128 v[200:203], v6 offset:160
    s_waitcnt lgkmcnt(6)
    v_mfma_f32_16x16x32_bf16 v[224:227], v[48:51], v[176:179], v[224:227]
    ds_read_b128 v[204:207], v6 offset:176
    s_waitcnt lgkmcnt(6)
    v_mfma_f32_16x16x32_bf16 v[224:227], v[52:55], v[180:183], v[224:227]
    ds_read_b128 v[208:211], v6 offset:192
    s_waitcnt lgkmcnt(6)
    v_mfma_f32_16x16x32_bf16 v[224:227], v[56:59], v[184:187], v[224:227]
    ds_read_b128 v[212:215], v6 offset:208
    s_waitcnt lgkmcnt(6)
    v_mfma_f32_16x16x32_bf16 v[224:227], v[60:63], v[188:191], v[224:227]
    ds_read_b128 v[216:219], v6 offset:224
    s_waitcnt lgkmcnt(6)
    v_mfma_f32_16x16x32_bf16 v[224:227], v[64:67], v[192:195], v[224:227]
    ds_read_b128 v[220:223], v6 offset:240
    s_waitcnt lgkmcnt(6)
    v_mfma_f32_16x16x32_bf16 v[224:227], v[68:71], v[196:199], v[224:227]
    s_waitcnt lgkmcnt(5)
    v_mfma_f32_16x16x32_bf16 v[224:227], v[72:75], v[200:203], v[224:227]
    s_waitcnt lgkmcnt(4)
    v_mfma_f32_16x16x32_bf16 v[224:227], v[76:79], v[204:207], v[224:227]
    s_waitcnt lgkmcnt(3)
    v_mfma_f32_16x16x32_bf16 v[224:227], v[80:83], v[208:211], v[224:227]
    s_waitcnt lgkmcnt(2)
    v_mfma_f32_16x16x32_bf16 v[224:227], v[84:87], v[212:215], v[224:227]
    s_waitcnt lgkmcnt(1)
    v_mfma_f32_16x16x32_bf16 v[224:227], v[88:91], v[216:219], v[224:227]
    s_waitcnt lgkmcnt(0)
    v_mfma_f32_16x16x32_bf16 v[224:227], v[92:95], v[220:223], v[224:227]
    ds_read_b64_tr_b16 v[96:97], v236 offset:0
    ds_read_b64_tr_b16 v[98:99], v237 offset:0
    ds_read_b64_tr_b16 v[112:113], v238 offset:0
    ds_read_b64_tr_b16 v[114:115], v239 offset:0
    ds_read_b64_tr_b16 v[128:129], v240 offset:0
    ds_read_b64_tr_b16 v[130:131], v241 offset:0
    ds_read_b64_tr_b16 v[144:145], v242 offset:0
    ds_read_b64_tr_b16 v[146:147], v243 offset:0
    ds_read_b64_tr_b16 v[100:101], v236 offset:32768
    ds_read_b64_tr_b16 v[102:103], v237 offset:32768
    ds_read_b64_tr_b16 v[116:117], v238 offset:32768
    ds_read_b64_tr_b16 v[118:119], v239 offset:32768
    v_max3_f32 v8, v224, v225, v226
    v_max_f32 v8, v8, v227
    ds_max_f32 v7, v8
    s_waitcnt lgkmcnt(0)
    s_barrier
    ds_read_b32 v8, v7
    ds_read_b64_tr_b16 v[132:133], v240 offset:32768
    ds_read_b64_tr_b16 v[134:135], v241 offset:32768
    ds_read_b64_tr_b16 v[148:149], v242 offset:32768
    ds_read_b64_tr_b16 v[150:151], v243 offset:32768
    ds_read_b64_tr_b16 v[104:105], v244 offset:0
    ds_read_b64_tr_b16 v[106:107], v245 offset:0
    ds_read_b64_tr_b16 v[120:121], v246 offset:0
    ds_read_b64_tr_b16 v[122:123], v247 offset:0
    ds_read_b64_tr_b16 v[136:137], v248 offset:0
    ds_read_b64_tr_b16 v[138:139], v249 offset:0
    ds_read_b64_tr_b16 v[152:153], v250 offset:0
    ds_read_b64_tr_b16 v[154:155], v30 offset:0
    s_waitcnt lgkmcnt(12)
    v_mul_f32 v20, s72, v8
    v_fma_f32 v224, v224, s72, -v20
    v_fma_f32 v225, v225, s72, -v20
    v_fma_f32 v226, v226, s72, -v20
    v_fma_f32 v227, v227, s72, -v20
    v_exp_f32 v224, v224
    v_exp_f32 v225, v225
    v_exp_f32 v226, v226
    v_exp_f32 v227, v227
    v_cvt_pk_bf16_f32 v8, v224, v225
    v_cvt_pk_bf16_f32 v9, v226, v227
    ds_write_b64 v17, v[8:9]
    v_add_f32 v10, v224, v225
    v_add_f32 v11, v226, v227
    v_add_f32 v10, v10, v11
    v_mul_f32 v10, 0x4b800000, v10
    v_cvt_u32_f32 v10, v10
    ds_add_u32 v7, v10 offset:64
    ds_read_b64_tr_b16 v[108:109], v244 offset:32768
    ds_read_b64_tr_b16 v[110:111], v245 offset:32768
    ds_read_b64_tr_b16 v[124:125], v246 offset:32768
    ds_read_b64_tr_b16 v[126:127], v247 offset:32768
    ds_read_b64_tr_b16 v[140:141], v248 offset:32768
    ds_read_b64_tr_b16 v[142:143], v249 offset:32768
    ds_read_b64_tr_b16 v[156:157], v250 offset:32768
    ds_read_b64_tr_b16 v[158:159], v30 offset:32768
    s_waitcnt lgkmcnt(8)
    s_barrier
    ds_read_b128 v[32:35], v232
    ds_read_b128 v[36:39], v233
    ds_read_b128 v[40:43], v234
    ds_read_b128 v[44:47], v235
    ds_read_b32 v21, v7 offset:64
    s_waitcnt lgkmcnt(4)
    v_mfma_f32_16x16x32_bf16 v[160:163], v[96:99], v[32:35], 0
    v_mfma_f32_16x16x32_bf16 v[164:167], v[112:115], v[32:35], 0
    v_mfma_f32_16x16x32_bf16 v[168:171], v[128:131], v[32:35], 0
    v_mfma_f32_16x16x32_bf16 v[172:175], v[144:147], v[32:35], 0
    s_cmp_lg_u32 s35, 0
    s_cbranch_scc1 L_aml_79
    s_waitcnt lgkmcnt(0)
    v_cvt_f32_u32 v21, v21
    v_mul_f32 v21, 0x33800000, v21
    s_mov_b64 exec, 0xffff
    buffer_store_dwordx2 v[20:21], v19, s[40:43], s58 offen sc1
    s_mov_b64 exec, -1
L_aml_79:
    s_waitcnt lgkmcnt(3)
    v_mfma_f32_16x16x32_bf16 v[160:163], v[100:103], v[36:39], v[160:163]
    v_mfma_f32_16x16x32_bf16 v[164:167], v[116:119], v[36:39], v[164:167]
    v_mfma_f32_16x16x32_bf16 v[168:171], v[132:135], v[36:39], v[168:171]
    v_mfma_f32_16x16x32_bf16 v[172:175], v[148:151], v[36:39], v[172:175]
    s_waitcnt lgkmcnt(2)
    v_mfma_f32_16x16x32_bf16 v[160:163], v[104:107], v[40:43], v[160:163]
    v_mfma_f32_16x16x32_bf16 v[164:167], v[120:123], v[40:43], v[164:167]
    v_mfma_f32_16x16x32_bf16 v[168:171], v[136:139], v[40:43], v[168:171]
    v_mfma_f32_16x16x32_bf16 v[172:175], v[152:155], v[40:43], v[172:175]
    s_waitcnt lgkmcnt(1)
    v_mfma_f32_16x16x32_bf16 v[160:163], v[108:111], v[44:47], v[160:163]
    v_mfma_f32_16x16x32_bf16 v[164:167], v[124:127], v[44:47], v[164:167]
    v_mfma_f32_16x16x32_bf16 v[168:171], v[140:143], v[44:47], v[168:171]
    v_mfma_f32_16x16x32_bf16 v[172:175], v[156:159], v[44:47], v[172:175]
    v_xor_b32 v22, 64, v18
    v_add_u32 v22, 8192, v22
    s_nop 2
    v_cvt_pk_bf16_f32 v8, v160, v161
    v_cvt_pk_bf16_f32 v9, v162, v163
    v_cvt_pk_bf16_f32 v10, v164, v165
    v_cvt_pk_bf16_f32 v11, v166, v167
    v_cvt_pk_bf16_f32 v12, v168, v169
    v_cvt_pk_bf16_f32 v13, v170, v171
    v_cvt_pk_bf16_f32 v14, v172, v173
    v_cvt_pk_bf16_f32 v15, v174, v175
    v_permlane16_swap_b32 v8, v10
    v_permlane16_swap_b32 v9, v11
    v_permlane16_swap_b32 v12, v14
    v_permlane16_swap_b32 v13, v15
    s_mov_b32 vcc_lo, 0x00ff00ff
    s_mov_b32 vcc_hi, 0x00ff00ff
    v_cndmask_b32_dpp v24, v12, v8, vcc row_ror:8 row_mask:0xf bank_mask:0xf
    v_cndmask_b32_dpp v25, v13, v9, vcc row_ror:8 row_mask:0xf bank_mask:0xf
    v_cndmask_b32_dpp v26, v14, v10, vcc row_ror:8 row_mask:0xf bank_mask:0xf
    v_cndmask_b32_dpp v27, v15, v11, vcc row_ror:8 row_mask:0xf bank_mask:0xf
    buffer_store_dwordx4 v[24:27], v18, s[40:43], s57 offen sc1
    s_not_b64 vcc, vcc
    v_cndmask_b32_dpp v28, v12, v8, vcc row_ror:8 row_mask:0xf bank_mask:0xf
    v_cndmask_b32_dpp v29, v13, v9, vcc row_ror:8 row_mask:0xf bank_mask:0xf
    v_cndmask_b32_dpp v30, v14, v10, vcc row_ror:8 row_mask:0xf bank_mask:0xf
    v_cndmask_b32_dpp v31, v15, v11, vcc row_ror:8 row_mask:0xf bank_mask:0xf
    buffer_store_dwordx4 v[28:31], v22, s[40:43], s57 offen sc1
    s_and_b32 s74, s60, 0xfff
    s_xor_b32 s75, s74, 0xfff
    s_mov_b32 s76, 0xfff
    s_lshl_b32 s64, s39, 6
    s_add_u32 s64, s64, s38
    s_mul_i32 s64, s64, 4608
    s_lshl_b32 s65, s35, 9
    s_add_u32 s64, s64, s65
    s_add_u32 s57, s64, 327680
    s_barrier
    s_cmp_lg_u32 s39, 0
    s_cbranch_scc1 L_ppf_82
    v_min_u32 v4, 323, v0
    v_lshlrev_b32 v4, 7, v4
    s_mul_i32 s64, s38, 82944
    s_add_u32 s64, s64, 41472
    v_add_u32 v4, s64, v4
    global_load_dword v236, v4, s[26:27]
    s_branch L_lgj_80
L_ppf_82:
    s_cmp_gt_u32 s35, 4
    s_cbranch_scc1 L_lgp_84
    s_mul_i32 s56, s38, 82944
    s_add_u32 s48, s26, s56
    s_addc_u32 s49, s27, 0
    s_sub_u32 s50, 5308416, s56
    s_mov_b32 s51, 0x20000
    v_lshrrev_b32 v4, 1, v2
    v_mul_u32_u24 v4, 18, v4
    v_and_b32 v5, 1, v2
    v_add_u32 v4, v4, v5
    v_mul_u32_u24 v4, 1152, v4
    v_lshl_add_u32 v4, v3, 4, v4
    s_lshl_b32 s64, s35, 8
    v_add_u32 v4, s64, v4
    s_mov_b32 s64, 0
    s_mov_b32 s65, 41472
    s_cmp_eq_u32 s35, 4
    s_cselect_b32 s70, 0x00ff00ff, -1
    s_mov_b32 s71, s70
    s_mov_b64 exec, s[70:71]
    buffer_load_dwordx4 v[32:35], v4, s[48:51], s64 offen
    s_add_u32 s64, s64, 2304
    buffer_load_dwordx4 v[40:43], v4, s[48:51], s64 offen
    s_add_u32 s64, s64, 2304
    buffer_load_dwordx4 v[48:51], v4, s[48:51], s64 offen
    s_add_u32 s64, s64, 2304
    buffer_load_dwordx4 v[56:59], v4, s[48:51], s64 offen
    s_add_u32 s64, s64, 2304
    buffer_load_dwordx4 v[64:67], v4, s[48:51], s64 offen
    s_add_u32 s64, s64, 2304
    buffer_load_dwordx4 v[72:75], v4, s[48:51], s64 offen
    s_add_u32 s64, s64, 2304
    buffer_load_dwordx4 v[80:83], v4, s[48:51], s64 offen
    s_add_u32 s64, s64, 2304
    buffer_load_dwordx4 v[88:91], v4, s[48:51], s64 offen
    s_add_u32 s64, s64, 2304
    buffer_load_dwordx4 v[96:99], v4, s[48:51], s64 offen
    buffer_load_dwordx4 v[36:39], v4, s[48:51], s65 offen
    s_add_u32 s65, s65, 2304
    buffer_load_dwordx4 v[44:47], v4, s[48:51], s65 offen
    s_add_u32 s65, s65, 2304
    buffer_load_dwordx4 v[52:55], v4, s[48:51], s65 offen
    s_add_u32 s65, s65, 2304
    buffer_load_dwordx4 v[60:63], v4, s[48:51], s65 offen
    s_add_u32 s65, s65, 2304
    buffer_load_dwordx4 v[68:71], v4, s[48:51], s65 offen
    s_add_u32 s65, s65, 2304
    buffer_load_dwordx4 v[76:79], v4, s[48:51], s65 offen
    s_add_u32 s65, s65, 2304
    buffer_load_dwordx4 v[84:87], v4, s[48:51], s65 offen
    s_add_u32 s65, s65, 2304
    buffer_load_dwordx4 v[92:95], v4, s[48:51], s65 offen
    s_add_u32 s65, s65, 2304
    buffer_load_dwordx4 v[100:103], v4, s[48:51], s65 offen
    s_mov_b64 exec, -1
    v_and_b32 v28, 4, v3
    v_cmp_eq_u32 vcc, 0, v28
    v_mov_b32 v28, 0xffff
    s_nop 0
    v_cndmask_b32 v244, 0, v28, vcc
    v_xor_b32 v245, v244, v28
    v_lshlrev_b32 v246, 16, v244
    v_lshlrev_b32 v247, 16, v245
    v_and_b32 v248, 3, v3
    v_mul_u32_u24 v248, 0x5555, v248
    v_lshrrev_b32 v5, 3, v3
    v_mul_u32_u24 v5, 144, v5
    v_mad_u32_u24 v5, v2, 36, v5
    v_add_u32 v5, 131072, v5
    v_lshrrev_b32 v6, 5, v1
    v_mul_u32_u24 v6, 2304, v6
    v_lshl_add_u32 v6, v3, 5, v6
    v_and_b32 v7, 1, v2
    v_lshl_add_u32 v6, v7, 4, v6
    v_mov_b32 v18, s74
    v_mov_b32 v19, s75
    v_mov_b32 v140, 0
    v_mov_b32 v141, 0
    v_mov_b32 v142, 0
    v_mov_b32 v143, 0
    s_branch L_lgv_85
L_lgp_84:
    v_subrev_u32 v6, 320, v0
    v_min_u32 v6, 143, v6
    v_lshrrev_b32 v7, 2, v6
    v_and_b32 v6, 3, v6
    v_mul_u32_u24 v26, 9216, v6
    v_cmp_lt_u32 vcc, 17, v7
    s_nop 1
    v_cndmask_b32 v8, 0, 1, vcc
    v_mul_u32_u24 v9, 4320, v8
    v_lshl_add_u32 v26, v7, 4, v26
    v_add_u32 v26, v26, v9
    s_lshr_b32 s64, s38, 3
    s_mul_i32 s64, s64, 73728
    s_and_b32 s65, s38, 7
    s_mul_i32 s65, s65, 288
    s_add_u32 s64, s64, s65
    s_add_u32 s70, s64, 5242880
    s_add_u32 s71, s70, 36864
    v_lshl_add_u32 v27, v7, 2, v6
    v_lshlrev_b32 v27, 1, v27
    v_add_u32 v27, 131072, v27
    v_cmp_eq_u32 s[78:79], 1, v6
    v_cmp_eq_u32 s[72:73], 2, v6
    v_cmp_eq_u32 s[68:69], 3, v6
    s_mov_b32 s66, 2097152
L_lgl_86:
    buffer_load_dwordx4 v[32:35], v26, s[40:43], s70 offen offset:0 sc1
    buffer_load_dwordx4 v[36:39], v26, s[40:43], s70 offen offset:2304 sc1
    buffer_load_dwordx4 v[40:43], v26, s[40:43], s71 offen offset:0 sc1
    buffer_load_dwordx4 v[44:47], v26, s[40:43], s71 offen offset:2304 sc1
    v_mov_b32 v31, 1
    s_mov_b64 exec, 1
    ds_add_u32 v251, v31 offset:8
    s_mov_b64 exec, -1
    s_sub_u32 s66, s66, 1
    s_cmp_eq_u32 s66, 0
    s_waitcnt vmcnt(0)
    s_cbranch_scc1 L_lgd_87
    v_xor_b32 v32, s74, v32
    v_xor_b32 v33, s74, v33
    v_xor_b32 v34, s75, v34
    v_xor_b32 v35, s75, v35
    v_xor_b32 v36, s74, v36
    v_xor_b32 v37, s74, v37
    v_xor_b32 v38, s75, v38
    v_xor_b32 v39, s75, v39
    v_xor_b32 v40, s74, v40
    v_xor_b32 v41, s74, v41
    v_xor_b32 v42, s75, v42
    v_xor_b32 v43, s75, v43
    v_xor_b32 v44, s74, v44
    v_xor_b32 v45, s74, v45
    v_xor_b32 v46, s75, v46
    v_xor_b32 v47, s75, v47
    v_or3_b32 v48, v32, v33, v34
    v_or3_b32 v49, v35, v36, v37
    v_or3_b32 v48, v48, v38, v39
    v_or3_b32 v49, v49, v40, v41
    v_or3_b32 v48, v48, v42, v43
    v_or3_b32 v49, v49, v44, v45
    v_or3_b32 v48, v48, v46, v47
    v_or_b32 v48, v48, v49
    v_and_b32 v48, s76, v48
    v_cmp_ne_u32 vcc, 0, v48
    s_cbranch_vccz L_lgd_87
    s_sleep 4
    s_branch L_lgl_86
L_lgd_87:
    v_pk_add_f32 v[32:33], v[32:33], v[40:41]
    v_pk_add_f32 v[34:35], v[34:35], v[42:43]
    v_pk_add_f32 v[36:37], v[36:37], v[44:45]
    v_pk_add_f32 v[38:39], v[38:39], v[46:47]
    v_add_f32_dpp v32, v32, v32 quad_perm:[1,0,3,2] row_mask:0xf bank_mask:0xf
    v_add_f32_dpp v33, v33, v33 quad_perm:[1,0,3,2] row_mask:0xf bank_mask:0xf
    v_add_f32_dpp v34, v34, v34 quad_perm:[1,0,3,2] row_mask:0xf bank_mask:0xf
    v_add_f32_dpp v35, v35, v35 quad_perm:[1,0,3,2] row_mask:0xf bank_mask:0xf
    v_add_f32_dpp v36, v36, v36 quad_perm:[1,0,3,2] row_mask:0xf bank_mask:0xf
    v_add_f32_dpp v37, v37, v37 quad_perm:[1,0,3,2] row_mask:0xf bank_mask:0xf
    v_add_f32_dpp v38, v38, v38 quad_perm:[1,0,3,2] row_mask:0xf bank_mask:0xf
    v_add_f32_dpp v39, v39, v39 quad_perm:[1,0,3,2] row_mask:0xf bank_mask:0xf
    v_add_f32_dpp v32, v32, v32 quad_perm:[2,3,0,1] row_mask:0xf bank_mask:0xf
    v_add_f32_dpp v33, v33, v33 quad_perm:[2,3,0,1] row_mask:0xf bank_mask:0xf
    v_add_f32_dpp v34, v34, v34 quad_perm:[2,3,0,1] row_mask:0xf bank_mask:0xf
    v_add_f32_dpp v35, v35, v35 quad_perm:[2,3,0,1] row_mask:0xf bank_mask:0xf
    v_add_f32_dpp v36, v36, v36 quad_perm:[2,3,0,1] row_mask:0xf bank_mask:0xf
    v_add_f32_dpp v37, v37, v37 quad_perm:[2,3,0,1] row_mask:0xf bank_mask:0xf
    v_add_f32_dpp v38, v38, v38 quad_perm:[2,3,0,1] row_mask:0xf bank_mask:0xf
    v_add_f32_dpp v39, v39, v39 quad_perm:[2,3,0,1] row_mask:0xf bank_mask:0xf
    v_cndmask_b32 v32, v32, v33, s[78:79]
    v_cndmask_b32 v32, v32, v34, s[72:73]
    v_cndmask_b32 v32, v32, v35, s[68:69]
    v_cndmask_b32 v36, v36, v37, s[78:79]
    v_cndmask_b32 v36, v36, v38, s[72:73]
    v_cndmask_b32 v36, v36, v39, s[68:69]
    v_cvt_pk_bf16_f32 v9, v32, v36
    v_lshlrev_b32 v8, 16, v9
    v_and_b32 v12, 0xffff0000, v9
    v_mul_f32 v9, v8, v8
    v_mul_f32 v9, 0x3d372713, v9
    v_fma_f32 v9, v9, v8, v8
    v_mul_f32 v9, 0xc0135761, v9
    v_exp_f32 v9, v9
    s_nop 0
    v_add_f32 v9, 1.0, v9
    v_rcp_f32 v9, v9
    s_nop 0
    v_mul_f32 v8, v8, v9
    v_cvt_pk_bf16_f32 v8, v8, v8
    v_lshlrev_b32 v8, 16, v8
    v_mul_f32 v8, v8, v12
    v_cvt_pk_bf16_f32 v8, v8, v8
    s_cmp_eq_u32 s35, 7
    s_cselect_b32 exec_lo, 0xffff, -1
    s_cselect_b32 exec_hi, 0, -1
    ds_write_b16 v27, v8
    s_mov_b64 exec, -1
L_lgv_85:
    s_waitcnt lgkmcnt(0)
    s_barrier
    s_cmp_gt_u32 s35, 4
    s_cbranch_scc1 L_lgj_80
    ds_read2_b32 v[8:9], v5 offset0:0 offset1:1
    ds_read2_b32 v[10:11], v5 offset0:2 offset1:3
    ds_read2_b32 v[12:13], v5 offset0:4 offset1:5
    ds_read2_b32 v[14:15], v5 offset0:6 offset1:7
    ds_read_b32 v16, v5 offset:32
    s_waitcnt vmcnt(0)
    s_waitcnt lgkmcnt(3)
    v_and_b32 v104, v8, v244
    v_and_b32 v105, v8, v245
    v_and_b32 v106, v8, v246
    v_and_b32 v107, v8, v247
    v_and_b32 v108, v9, v244
    v_and_b32 v109, v9, v245
    v_and_b32 v110, v9, v246
    v_and_b32 v111, v9, v247
    v_smfmac_f32_16x16x64_bf16 v[140:143], v[104:107], v[32:39], v248
    v_and_b32 v112, v10, v244
    v_and_b32 v113, v10, v245
    v_and_b32 v114, v10, v246
    v_and_b32 v115, v10, v247
    v_smfmac_f32_16x16x64_bf16 v[140:143], v[108:111], v[40:47], v248
    v_and_b32 v104, v11, v244
    v_and_b32 v105, v11, v245
    v_and_b32 v106, v11, v246
    v_and_b32 v107, v11, v247
    v_smfmac_f32_16x16x64_bf16 v[140:143], v[112:115], v[48:55], v248
    s_waitcnt lgkmcnt(0)
    v_and_b32 v108, v12, v244
    v_and_b32 v109, v12, v245
    v_and_b32 v110, v12, v246
    v_and_b32 v111, v12, v247
    v_smfmac_f32_16x16x64_bf16 v[140:143], v[104:107], v[56:63], v248
    v_and_b32 v112, v13, v244
    v_and_b32 v113, v13, v245
    v_and_b32 v114, v13, v246
    v_and_b32 v115, v13, v247
    v_smfmac_f32_16x16x64_bf16 v[140:143], v[108:111], v[64:71], v248
    v_and_b32 v104, v14, v244
    v_and_b32 v105, v14, v245
    v_and_b32 v106, v14, v246
    v_and_b32 v107, v14, v247
    v_smfmac_f32_16x16x64_bf16 v[140:143], v[112:115], v[72:79], v248
    v_and_b32 v108, v15, v244
    v_and_b32 v109, v15, v245
    v_and_b32 v110, v15, v246
    v_and_b32 v111, v15, v247
    v_smfmac_f32_16x16x64_bf16 v[140:143], v[104:107], v[80:87], v248
    v_and_b32 v112, v16, v244
    v_and_b32 v113, v16, v245
    v_and_b32 v114, v16, v246
    v_and_b32 v115, v16, v247
    v_smfmac_f32_16x16x64_bf16 v[140:143], v[108:111], v[88:95], v248
    s_nop 0
    v_smfmac_f32_16x16x64_bf16 v[140:143], v[112:115], v[96:103], v248
    s_nop 7
    v_add_u32 v140, 0x800, v140
    v_bfi_b32 v140, s76, v18, v140
    v_add_u32 v141, 0x800, v141
    v_bfi_b32 v141, s76, v18, v141
    v_add_u32 v142, 0x800, v142
    v_bfi_b32 v142, s76, v19, v142
    v_add_u32 v143, 0x800, v143
    v_bfi_b32 v143, s76, v19, v143
    s_mov_b64 exec, s[70:71]
    buffer_store_dwordx4 v[140:143], v6, s[40:43], s57 offen sc1
    s_mov_b64 exec, -1
L_lgj_80:
    s_lshl_b32 s64, s39, 6
    s_add_u32 s38, s38, s64
    s_cmp_ge_u32 s38, 72
    s_cbranch_scc1 L_finend_88
    s_mov_b32 s48, s28
    s_mov_b32 s49, s29
    s_mov_b32 s50, 2304
    s_mov_b32 s51, 0x20000
    s_lshl_b32 s56, s38, 5
    v_lshlrev_b32 v6, 1, v3
    v_add_u32 v7, s56, v6
    global_load_ushort v20, v7, s[8:9]
    v_lshrrev_b32 v4, 2, v0
    v_mul_u32_u24 v4, 4608, v4
    v_and_b32 v5, 3, v0
    v_lshl_add_u32 v4, v5, 4, v4
    s_lshl_b32 s57, s38, 6
    s_add_u32 s57, s57, 327680
    v_lshl_add_u32 v5, v5, 2, v2
    v_lshlrev_b32 v5, 5, v5
    s_lshl_b32 s64, s35, 2
    v_add_u32 v5, s64, v5
    v_lshlrev_b32 v7, 5, v3
    s_mov_b32 s66, 2097152
L_fp_89:
    buffer_load_dwordx4 v[8:11], v4, s[40:43], s57 offen sc1
    s_sub_u32 s66, s66, 1
    s_cmp_eq_u32 s66, 0
    s_waitcnt vmcnt(0)
    s_cbranch_scc1 L_fpd_90
    v_xor_b32 v8, s74, v8
    v_xor_b32 v9, s74, v9
    v_xor_b32 v10, s75, v10
    v_xor_b32 v11, s75, v11
    v_or3_b32 v12, v8, v9, v10
    v_or_b32 v12, v12, v11
    v_and_b32 v12, s76, v12
    v_cmp_ne_u32 vcc, 0, v12
    s_cbranch_vccnz L_fp_89
L_fpd_90:
    v_add_f32_dpp v8, v8, v8 row_ror:4 row_mask:0xf bank_mask:0xf
    v_add_f32_dpp v9, v9, v9 row_ror:4 row_mask:0xf bank_mask:0xf
    v_add_f32_dpp v10, v10, v10 row_ror:4 row_mask:0xf bank_mask:0xf
    v_add_f32_dpp v11, v11, v11 row_ror:4 row_mask:0xf bank_mask:0xf
    v_add_f32_dpp v8, v8, v8 row_ror:8 row_mask:0xf bank_mask:0xf
    v_add_f32_dpp v9, v9, v9 row_ror:8 row_mask:0xf bank_mask:0xf
    v_add_f32_dpp v10, v10, v10 row_ror:8 row_mask:0xf bank_mask:0xf
    v_add_f32_dpp v11, v11, v11 row_ror:8 row_mask:0xf bank_mask:0xf
    v_permlane16_swap_b32 v8, v9
    s_nop 0
    v_permlane16_swap_b32 v10, v11
    v_add_f32 v8, v8, v9
    v_add_f32 v10, v10, v11
    s_nop 1
    v_permlane32_swap_b32 v8, v10
    v_add_f32 v8, v8, v10
    ds_write_b32 v5, v8
    s_waitcnt lgkmcnt(0)
    s_barrier
    s_cmp_lg_u32 s35, 0
    s_cbranch_scc1 L_finend_88
    ds_read_b128 v[12:15], v7 offset:16
    ds_read_b128 v[8:11], v7
    v_lshlrev_b32 v20, 16, v20
    s_waitcnt lgkmcnt(1)
    v_pk_add_f32 v[12:13], v[12:13], v[14:15]
    v_add_f32 v12, v12, v13
    v_cvt_pk_bf16_f32 v12, v12, v12
    v_lshlrev_b32 v12, 16, v12
    v_mul_f32 v13, 0xbfb8aa3b, v12
    v_exp_f32 v13, v13
    s_waitcnt lgkmcnt(0)
    v_pk_add_f32 v[8:9], v[8:9], v[10:11]
    v_add_f32 v13, 1.0, v13
    v_rcp_f32 v13, v13
    v_add_f32 v8, v8, v9
    v_cvt_pk_bf16_f32 v8, v8, v8
    v_lshlrev_b32 v8, 16, v8
    v_mul_f32 v12, v12, v13
    v_cvt_pk_bf16_f32 v12, v12, v12
    v_lshlrev_b32 v12, 16, v12
    v_mul_f32 v8, v8, v12
    v_cvt_pk_bf16_f32 v8, v8, v8
    v_lshlrev_b32 v8, 16, v8
    v_add_f32 v8, v8, v20
    v_cvt_pk_bf16_f32 v8, v8, v8
    s_mov_b64 exec, 0xffff
    buffer_store_short v8, v6, s[48:51], s56 offen
    s_cmp_lg_u32 s38, 0
    s_cbranch_scc1 L_cep_91
    s_mov_b64 exec, 1
    v_mov_b32 v8, s60
    buffer_store_dword v8, v1, s[40:43], 0 offen offset:0
L_cep_91:
    s_mov_b64 exec, -1
L_finend_88:
    s_endpgm
L_roleF:
    s_mov_b32 s67, 16777216
L_hold_92:
    ds_read_b32 v31, v251 offset:0
    s_sub_u32 s67, s67, 1
    s_cmp_eq_u32 s67, 0
    s_cbranch_scc1 L_holdd_93
    s_sleep 2
    s_waitcnt lgkmcnt(0)
    v_cmp_gt_u32 vcc, 1, v31
    s_cbranch_vccnz L_hold_92
L_holdd_93:
    s_waitcnt lgkmcnt(0)
    v_lshlrev_b32 v4, 3, v1
    v_add_u32 v4, 160768, v4
    ds_read2_b32 v[18:19], v4 offset1:1
    s_waitcnt lgkmcnt(0)
    v_mov_b32 v249, v18
    v_mov_b32 v250, v19
L_F_go:
    s_setprio 0
    s_sub_u32 s39, s37, 24
    s_lshl_b32 s38, s36, 3
    s_add_u32 s38, s38, s39
    v_lshrrev_b32 v4, 3, v3
    v_mul_u32_u24 v4, 1152, v4
    s_lshl_b32 s64, s39, 2
    v_add_u32 v7, s64, v2
    v_mad_u32_u24 v7, v7, 36, v4
    global_load_dwordx4 v[188:191], v7, s[8:9]
    global_load_dwordx2 v[192:193], v7, s[8:9] offset:16
    global_load_dwordx3 v[236:238], v7, s[8:9] offset:24
    v_lshrrev_b32 v4, 1, v2
    v_mul_u32_u24 v4, 18, v4
    v_and_b32 v5, 1, v2
    v_add_u32 v4, v4, v5
    s_mul_i32 s64, s39, 72
    s_lshl_b32 s65, s35, 1
    s_add_u32 s64, s64, s65
    v_add_u32 v4, s64, v4
    v_mul_u32_u24 v4, 9216, v4
    s_mul_i32 s64, s36, 1152
    v_add_u32 v4, s64, v4
    s_lshl_b32 s64, s35, 4
    v_add_u32 v5, s64, v3
    v_cmp_lt_u32 vcc, 71, v5
    v_subrev_u32 v6, 72, v5
    s_nop 0
    v_cndmask_b32 v5, v5, v6, vcc
    v_lshl_add_u32 v22, v5, 4, v4
    v_mov_b32 v23, 0
    v_mov_b32 v20, s22
    v_mov_b32 v21, s24
    v_cndmask_b32 v20, v20, v21, vcc
    v_mov_b32 v21, s23
    v_mov_b32 v6, s25
    v_cndmask_b32 v21, v21, v6, vcc
    v_lshl_add_u64 v[22:23], v[22:23], 0, v[20:21]
    s_mov_b32 s70, 331776
    s_mov_b32 s71, 0
    v_lshl_add_u64 v[24:25], v[22:23], 0, s[70:71]
    v_lshl_add_u32 v4, v3, 4, v4
    v_add_u32 v4, 896, v4
    v_add_u32 v5, 331776, v4
    s_cmp_eq_u32 s35, 0
    s_cbranch_scc1 L_fgo_94
    s_mov_b32 s67, 16777216
L_hold_95:
    ds_read_b32 v31, v251 offset:0
    s_sub_u32 s67, s67, 1
    s_cmp_eq_u32 s67, 0
    s_cbranch_scc1 L_holdd_96
    s_sleep 2
    s_waitcnt lgkmcnt(0)
    v_cmp_gt_u32 vcc, 2, v31
    s_cbranch_vccnz L_hold_95
L_holdd_96:
    s_waitcnt lgkmcnt(0)
L_fgo_94:
    s_cmp_lg_u32 s35, 0
    s_cbranch_scc1 L_fb8_97
    v_add_u32 v6, 147456, v4
    global_load_dwordx4 v[204:207], v6, s[24:25] nt
    v_add_u32 v6, 147456, v5
    global_load_dwordx4 v[208:211], v6, s[24:25] nt
L_fb8_97:
    global_load_dwordx4 v[196:199], v4, s[24:25] nt
    global_load_dwordx4 v[200:203], v5, s[24:25] nt
    s_mov_b32 s72, s35
    global_load_dwordx4 v[32:35], v[22:23], off nt
    global_load_dwordx4 v[36:39], v[24:25], off nt
    s_cmp_eq_u32 s72, 8
    s_cselect_b32 s70, 4294801408, 0
    s_cselect_b32 s71, -1, 0
    s_cselect_b32 s72, -1, s72
    s_add_u32 s70, s70, 18432
    s_add_u32 s72, s72, 1
    v_lshl_add_u64 v[22:23], v[22:23], 0, s[70:71]
    v_lshl_add_u64 v[24:25], v[24:25], 0, s[70:71]
    global_load_dwordx4 v[40:43], v[22:23], off nt
    global_load_dwordx4 v[44:47], v[24:25], off nt
    s_cmp_eq_u32 s72, 8
    s_cselect_b32 s70, 4294801408, 0
    s_cselect_b32 s71, -1, 0
    s_cselect_b32 s72, -1, s72
    s_add_u32 s70, s70, 18432
    s_add_u32 s72, s72, 1
    v_lshl_add_u64 v[22:23], v[22:23], 0, s[70:71]
    v_lshl_add_u64 v[24:25], v[24:25], 0, s[70:71]
    global_load_dwordx4 v[48:51], v[22:23], off nt
    global_load_dwordx4 v[52:55], v[24:25], off nt
    s_cmp_eq_u32 s72, 8
    s_cselect_b32 s70, 4294801408, 0
    s_cselect_b32 s71, -1, 0
    s_cselect_b32 s72, -1, s72
    s_add_u32 s70, s70, 18432
    s_add_u32 s72, s72, 1
    v_lshl_add_u64 v[22:23], v[22:23], 0, s[70:71]
    v_lshl_add_u64 v[24:25], v[24:25], 0, s[70:71]
    v_lshrrev_b32 v6, 3, v3
    v_lshl_add_u32 v6, v6, 2, v2
    v_mul_u32_u24 v6, 72, v6
    s_mul_i32 s64, s35, 576
    v_add_u32 v6, s64, v6
    s_lshl_b32 s64, s35, 2
    v_add_u32 v7, s64, v6
    s_waitcnt vmcnt(8)
    v_lshlrev_b32 v26, 16, v188
    v_and_b32 v27, 0xffff0000, v188
    v_sub_f32 v26, v26, v249
    v_sub_f32 v27, v27, v249
    v_cvt_pk_bf16_f32 v188, v26, v27
    v_lshlrev_b32 v26, 16, v188
    v_and_b32 v27, 0xffff0000, v188
    v_mul_f32 v26, v26, v250
    v_mul_f32 v27, v27, v250
    v_cvt_pk_bf16_f32 v188, v26, v27
    ds_write2_b32 v6, v188, v188 offset0:0 offset1:9
    v_lshlrev_b32 v26, 16, v189
    v_and_b32 v27, 0xffff0000, v189
    v_sub_f32 v26, v26, v249
    v_sub_f32 v27, v27, v249
    v_cvt_pk_bf16_f32 v189, v26, v27
    v_lshlrev_b32 v26, 16, v189
    v_and_b32 v27, 0xffff0000, v189
    v_mul_f32 v26, v26, v250
    v_mul_f32 v27, v27, v250
    v_cvt_pk_bf16_f32 v189, v26, v27
    ds_write2_b32 v6, v189, v189 offset0:1 offset1:10
    v_lshlrev_b32 v26, 16, v190
    v_and_b32 v27, 0xffff0000, v190
    v_sub_f32 v26, v26, v249
    v_sub_f32 v27, v27, v249
    v_cvt_pk_bf16_f32 v190, v26, v27
    v_lshlrev_b32 v26, 16, v190
    v_and_b32 v27, 0xffff0000, v190
    v_mul_f32 v26, v26, v250
    v_mul_f32 v27, v27, v250
    v_cvt_pk_bf16_f32 v190, v26, v27
    ds_write2_b32 v6, v190, v190 offset0:2 offset1:11
    v_lshlrev_b32 v26, 16, v191
    v_and_b32 v27, 0xffff0000, v191
    v_sub_f32 v26, v26, v249
    v_sub_f32 v27, v27, v249
    v_cvt_pk_bf16_f32 v191, v26, v27
    v_lshlrev_b32 v26, 16, v191
    v_and_b32 v27, 0xffff0000, v191
    v_mul_f32 v26, v26, v250
    v_mul_f32 v27, v27, v250
    v_cvt_pk_bf16_f32 v191, v26, v27
    ds_write2_b32 v6, v191, v191 offset0:3 offset1:12
    v_lshlrev_b32 v26, 16, v192
    v_and_b32 v27, 0xffff0000, v192
    v_sub_f32 v26, v26, v249
    v_sub_f32 v27, v27, v249
    v_cvt_pk_bf16_f32 v192, v26, v27
    v_lshlrev_b32 v26, 16, v192
    v_and_b32 v27, 0xffff0000, v192
    v_mul_f32 v26, v26, v250
    v_mul_f32 v27, v27, v250
    v_cvt_pk_bf16_f32 v192, v26, v27
    ds_write2_b32 v6, v192, v192 offset0:4 offset1:13
    v_lshlrev_b32 v26, 16, v193
    v_and_b32 v27, 0xffff0000, v193
    v_sub_f32 v26, v26, v249
    v_sub_f32 v27, v27, v249
    v_cvt_pk_bf16_f32 v193, v26, v27
    v_lshlrev_b32 v26, 16, v193
    v_and_b32 v27, 0xffff0000, v193
    v_mul_f32 v26, v26, v250
    v_mul_f32 v27, v27, v250
    v_cvt_pk_bf16_f32 v193, v26, v27
    ds_write2_b32 v6, v193, v193 offset0:5 offset1:14
    v_lshlrev_b32 v26, 16, v236
    v_and_b32 v27, 0xffff0000, v236
    v_sub_f32 v26, v26, v249
    v_sub_f32 v27, v27, v249
    v_cvt_pk_bf16_f32 v236, v26, v27
    v_lshlrev_b32 v26, 16, v236
    v_and_b32 v27, 0xffff0000, v236
    v_mul_f32 v26, v26, v250
    v_mul_f32 v27, v27, v250
    v_cvt_pk_bf16_f32 v236, v26, v27
    ds_write2_b32 v6, v236, v236 offset0:6 offset1:15
    v_lshlrev_b32 v26, 16, v237
    v_and_b32 v27, 0xffff0000, v237
    v_sub_f32 v26, v26, v249
    v_sub_f32 v27, v27, v249
    v_cvt_pk_bf16_f32 v237, v26, v27
    v_lshlrev_b32 v26, 16, v237
    v_and_b32 v27, 0xffff0000, v237
    v_mul_f32 v26, v26, v250
    v_mul_f32 v27, v27, v250
    v_cvt_pk_bf16_f32 v237, v26, v27
    ds_write2_b32 v6, v237, v237 offset0:7 offset1:16
    v_lshlrev_b32 v26, 16, v238
    v_and_b32 v27, 0xffff0000, v238
    v_sub_f32 v26, v26, v249
    v_sub_f32 v27, v27, v249
    v_cvt_pk_bf16_f32 v238, v26, v27
    v_lshlrev_b32 v26, 16, v238
    v_and_b32 v27, 0xffff0000, v238
    v_mul_f32 v26, v26, v250
    v_mul_f32 v27, v27, v250
    v_cvt_pk_bf16_f32 v238, v26, v27
    ds_write2_b32 v6, v238, v238 offset0:8 offset1:17
    ds_read2_b32 v[8:9], v7 offset0:0 offset1:1
    ds_read2_b32 v[10:11], v7 offset0:2 offset1:3
    ds_read2_b32 v[12:13], v7 offset0:4 offset1:5
    ds_read2_b32 v[14:15], v7 offset0:6 offset1:7
    ds_read_b32 v16, v7 offset:32
    v_mov_b32 v232, 0
    v_mov_b32 v228, 0
    v_mov_b32 v233, 0
    v_mov_b32 v229, 0
    v_mov_b32 v234, 0
    v_mov_b32 v230, 0
    v_mov_b32 v235, 0
    v_mov_b32 v231, 0
    s_waitcnt lgkmcnt(0)
    v_and_b32 v104, v8, v244
    v_and_b32 v105, v8, v245
    v_and_b32 v106, v8, v246
    v_and_b32 v107, v8, v247
    v_and_b32 v108, v9, v244
    v_and_b32 v109, v9, v245
    v_and_b32 v110, v9, v246
    v_and_b32 v111, v9, v247
    v_and_b32 v112, v10, v244
    v_and_b32 v113, v10, v245
    v_and_b32 v114, v10, v246
    v_and_b32 v115, v10, v247
    v_and_b32 v116, v11, v244
    v_and_b32 v117, v11, v245
    v_and_b32 v118, v11, v246
    v_and_b32 v119, v11, v247
    v_and_b32 v120, v12, v244
    v_and_b32 v121, v12, v245
    v_and_b32 v122, v12, v246
    v_and_b32 v123, v12, v247
    v_and_b32 v124, v13, v244
    v_and_b32 v125, v13, v245
    v_and_b32 v126, v13, v246
    v_and_b32 v127, v13, v247
    v_and_b32 v128, v14, v244
    v_and_b32 v129, v14, v245
    v_and_b32 v130, v14, v246
    v_and_b32 v131, v14, v247
    v_and_b32 v132, v15, v244
    v_and_b32 v133, v15, v245
    v_and_b32 v134, v15, v246
    v_and_b32 v135, v15, v247
    v_and_b32 v136, v16, v244
    v_and_b32 v137, v16, v245
    v_and_b32 v138, v16, v246
    v_and_b32 v139, v16, v247
    v_lshrrev_b32 v6, 5, v1
    v_mul_u32_u24 v6, 4608, v6
    v_lshl_add_u32 v6, v3, 5, v6
    v_and_b32 v7, 1, v2
    v_lshl_add_u32 v6, v7, 4, v6
    s_mul_i32 s65, s38, 9216
    s_add_u32 s65, s65, 5242880
    s_lshl_b32 s64, s35, 9
    s_add_u32 s58, s65, s64
    s_add_u32 s59, s65, 4096
    s_and_b32 s74, s60, 0xfff
    s_xor_b32 s75, s74, 0xfff
    s_mov_b32 s76, 0xfff
    v_mov_b32 v18, s74
    v_mov_b32 v19, s75
    s_lshl_b32 s64, s35, 10
    s_add_u32 s64, s64, 8192
    v_lshl_add_u32 v7, v1, 4, s64
    s_waitcnt vmcnt(6)
    v_smfmac_f32_16x16x64_bf16 v[228:231], v[104:107], v[196:203], v248
    s_cmp_lg_u32 s35, 0
    s_cbranch_scc1 L_fb8_98
    v_smfmac_f32_16x16x64_bf16 v[228:231], v[136:139], v[204:211], v248
L_fb8_98:
    s_nop 7
    ds_write_b128 v7, v[228:231]
    global_load_dwordx4 v[56:59], v[22:23], off nt
    global_load_dwordx4 v[60:63], v[24:25], off nt
    s_cmp_eq_u32 s72, 8
    s_cselect_b32 s70, 4294801408, 0
    s_cselect_b32 s71, -1, 0
    s_cselect_b32 s72, -1, s72
    s_add_u32 s70, s70, 18432
    s_add_u32 s72, s72, 1
    v_lshl_add_u64 v[22:23], v[22:23], 0, s[70:71]
    v_lshl_add_u64 v[24:25], v[24:25], 0, s[70:71]
    global_load_dwordx4 v[64:67], v[22:23], off nt
    global_load_dwordx4 v[68:71], v[24:25], off nt
    s_cmp_eq_u32 s72, 8
    s_cselect_b32 s70, 4294801408, 0
    s_cselect_b32 s71, -1, 0
    s_cselect_b32 s72, -1, s72
    s_add_u32 s70, s70, 18432
    s_add_u32 s72, s72, 1
    v_lshl_add_u64 v[22:23], v[22:23], 0, s[70:71]
    v_lshl_add_u64 v[24:25], v[24:25], 0, s[70:71]
    global_load_dwordx4 v[72:75], v[22:23], off nt
    global_load_dwordx4 v[76:79], v[24:25], off nt
    s_cmp_eq_u32 s72, 8
    s_cselect_b32 s70, 4294801408, 0
    s_cselect_b32 s71, -1, 0
    s_cselect_b32 s72, -1, s72
    s_add_u32 s70, s70, 18432
    s_add_u32 s72, s72, 1
    v_lshl_add_u64 v[22:23], v[22:23], 0, s[70:71]
    v_lshl_add_u64 v[24:25], v[24:25], 0, s[70:71]
    global_load_dwordx4 v[80:83], v[22:23], off nt
    global_load_dwordx4 v[84:87], v[24:25], off nt
    s_cmp_eq_u32 s72, 8
    s_cselect_b32 s70, 4294801408, 0
    s_cselect_b32 s71, -1, 0
    s_cselect_b32 s72, -1, s72
    s_add_u32 s70, s70, 18432
    s_add_u32 s72, s72, 1
    v_lshl_add_u64 v[22:23], v[22:23], 0, s[70:71]
    v_lshl_add_u64 v[24:25], v[24:25], 0, s[70:71]
    global_load_dwordx4 v[88:91], v[22:23], off nt
    global_load_dwordx4 v[92:95], v[24:25], off nt
    s_cmp_eq_u32 s72, 8
    s_cselect_b32 s70, 4294801408, 0
    s_cselect_b32 s71, -1, 0
    s_cselect_b32 s72, -1, s72
    s_add_u32 s70, s70, 18432
    s_add_u32 s72, s72, 1
    v_lshl_add_u64 v[22:23], v[22:23], 0, s[70:71]
    v_lshl_add_u64 v[24:25], v[24:25], 0, s[70:71]
    global_load_dwordx4 v[96:99], v[22:23], off nt
    global_load_dwordx4 v[100:103], v[24:25], off nt
    s_waitcnt lgkmcnt(0)
    s_barrier
    s_cmp_lg_u32 s35, 0
    s_cbranch_scc1 L_fb8_99
    ds_read_b128 v[140:143], v7 offset:0
    ds_read_b128 v[144:147], v7 offset:1024
    ds_read_b128 v[148:151], v7 offset:2048
    ds_read_b128 v[152:155], v7 offset:3072
    ds_read_b128 v[156:159], v7 offset:4096
    ds_read_b128 v[160:163], v7 offset:5120
    ds_read_b128 v[164:167], v7 offset:6144
    ds_read_b128 v[168:171], v7 offset:7168
    s_waitcnt lgkmcnt(6)
    v_pk_add_f32 v[140:141], v[140:141], v[144:145]
    v_pk_add_f32 v[142:143], v[142:143], v[146:147]
    s_waitcnt lgkmcnt(5)
    v_pk_add_f32 v[140:141], v[140:141], v[148:149]
    v_pk_add_f32 v[142:143], v[142:143], v[150:151]
    s_waitcnt lgkmcnt(4)
    v_pk_add_f32 v[140:141], v[140:141], v[152:153]
    v_pk_add_f32 v[142:143], v[142:143], v[154:155]
    s_waitcnt lgkmcnt(3)
    v_pk_add_f32 v[140:141], v[140:141], v[156:157]
    v_pk_add_f32 v[142:143], v[142:143], v[158:159]
    s_waitcnt lgkmcnt(2)
    v_pk_add_f32 v[140:141], v[140:141], v[160:161]
    v_pk_add_f32 v[142:143], v[142:143], v[162:163]
    s_waitcnt lgkmcnt(1)
    v_pk_add_f32 v[140:141], v[140:141], v[164:165]
    v_pk_add_f32 v[142:143], v[142:143], v[166:167]
    s_waitcnt lgkmcnt(0)
    v_pk_add_f32 v[140:141], v[140:141], v[168:169]
    v_pk_add_f32 v[142:143], v[142:143], v[170:171]
    v_add_u32 v228, 0x800, v140
    v_bfi_b32 v228, s76, v18, v228
    v_add_u32 v229, 0x800, v141
    v_bfi_b32 v229, s76, v18, v229
    v_add_u32 v230, 0x800, v142
    v_bfi_b32 v230, s76, v19, v230
    v_add_u32 v231, 0x800, v143
    v_bfi_b32 v231, s76, v19, v231
L_fb8_99:
    v_min_u32 v4, 323, v0
    v_lshlrev_b32 v4, 7, v4
    s_mul_i32 s64, s38, 82944
    v_add_u32 v4, s64, v4
    global_load_dword v194, v4, s[26:27]
    s_waitcnt vmcnt(17)
    v_smfmac_f32_16x16x64_bf16 v[232:235], v[104:107], v[32:39], v248
    s_waitcnt vmcnt(15)
    v_smfmac_f32_16x16x64_bf16 v[232:235], v[108:111], v[40:47], v248
    s_waitcnt vmcnt(13)
    v_smfmac_f32_16x16x64_bf16 v[232:235], v[112:115], v[48:55], v248
    s_waitcnt vmcnt(11)
    v_smfmac_f32_16x16x64_bf16 v[232:235], v[116:119], v[56:63], v248
    s_waitcnt vmcnt(9)
    v_smfmac_f32_16x16x64_bf16 v[232:235], v[120:123], v[64:71], v248
    s_waitcnt vmcnt(7)
    v_smfmac_f32_16x16x64_bf16 v[232:235], v[124:127], v[72:79], v248
    s_waitcnt vmcnt(5)
    v_smfmac_f32_16x16x64_bf16 v[232:235], v[128:131], v[80:87], v248
    s_waitcnt vmcnt(3)
    v_smfmac_f32_16x16x64_bf16 v[232:235], v[132:135], v[88:95], v248
    s_waitcnt vmcnt(1)
    v_smfmac_f32_16x16x64_bf16 v[232:235], v[136:139], v[96:103], v248
    s_setprio 2
    s_nop 6
    v_add_u32 v232, 0x800, v232
    v_bfi_b32 v232, s76, v18, v232
    v_add_u32 v233, 0x800, v233
    v_bfi_b32 v233, s76, v18, v233
    v_add_u32 v234, 0x800, v234
    v_bfi_b32 v234, s76, v19, v234
    v_add_u32 v235, 0x800, v235
    v_bfi_b32 v235, s76, v19, v235
    buffer_store_dwordx4 v[232:235], v6, s[40:43], s58 offen sc1
    s_cmp_lg_u32 s35, 0
    s_cbranch_scc1 L_fb8_100
    buffer_store_dwordx4 v[228:231], v6, s[40:43], s59 offen sc1
L_fb8_100:
    s_barrier
    v_min_u32 v4, 323, v0
    v_lshlrev_b32 v4, 7, v4
    s_mul_i32 s64, s38, 82944
    s_add_u32 s64, s64, 41472
    v_add_u32 v4, s64, v4
    global_load_dword v194, v4, s[26:27]
L_end:
    s_endpgm
.section .rodata,"a"
.p2align 6
.amdhsa_kernel recurrent_scan__compressed_kv_cla__geglu_ffn__decode_kernel
  .amdhsa_next_free_vgpr 256
  .amdhsa_next_free_sgpr 102
  .amdhsa_accum_offset 256
  .amdhsa_group_segment_fixed_size 0
  .amdhsa_kernarg_size 104
  .amdhsa_user_sgpr_count 2
  .amdhsa_user_sgpr_kernarg_segment_ptr 1
  .amdhsa_system_sgpr_workgroup_id_x 1
  .amdhsa_float_denorm_mode_32 3
.end_amdhsa_kernel
```
